```python
import torch

def _softmax(x, axis=-1):
    return torch.softmax(x, dim=axis)
def _gelu(x):
    return torch.nn.functional.gelu(x, approximate="tanh")
def _silu(x):
    return torch.nn.functional.silu(x)
def _sigmoid(x):
    return torch.sigmoid(x)
def _layernorm(x, axis=-1, eps=1e-5):
    m = x.mean(dim=axis, keepdim=True)
    v = x.var(dim=axis, keepdim=True, unbiased=False)
    return (x - m) / torch.sqrt(v + eps)
def _scatter_add(tgt, idx, src, axis=0):
    return tgt.clone().index_add_(axis, idx, src)
def _segment_sum(src, seg, n):
    out = torch.zeros((n,) + src.shape[1:], dtype=src.dtype)
    return out.index_add_(0, seg, src)
def _pad(x, pw):
    flat = tuple(v for pair in reversed(pw) for v in pair)
    return torch.nn.functional.pad(x, flat)

kernel_name = 'gated_mix__linear_attn_block__dense_activation_silu__prompt'

def setup_inputs():

    _w = (lambda a: (lambda t: t.to(torch.bfloat16) if t.is_floating_point() else t)(torch.as_tensor(a)))
    def _A_setup():
        B, S, D = 1, 2048, 512
        return {
            "x": _w((lambda *s: torch.randn(*s, dtype=torch.bfloat16) * 0.1)(B, S, D)),
            "wqkv": _w((lambda *s: torch.randn(*s, dtype=torch.bfloat16) * 0.8)(D, 3 * D)),
            "wo": _w((lambda *s: torch.randn(*s, dtype=torch.bfloat16) * 0.4)(D, D)),
        }
    _A_in = _A_setup()

    def _B_setup():
        B, S, D, F = 1, 2048, 512, 1376
        return {
            "x": _w((lambda *s: torch.randn(*s, dtype=torch.bfloat16) * 0.1)(B, S, D)),
            "w1": _w((lambda *s: torch.randn(*s, dtype=torch.bfloat16) * 3.2)(D, F) * (D ** -0.5)),
            "w2": _w((lambda *s: torch.randn(*s, dtype=torch.bfloat16) * 3.2)(F, D) * (F ** -0.5)),
        }
    _B_in = _B_setup()

    return {
        "A_x": _A_in["x"],
        "A_wqkv": _A_in["wqkv"],
        "A_wo": _A_in["wo"],
        "B_x": _B_in["x"],
        "B_w1": _B_in["w1"],
        "B_w2": _B_in["w2"],
        "gate_w": _w((lambda *s: torch.randn(*s, dtype=torch.bfloat16) * 0.1)(512) * 16.0),
    }

def reference(A_x, A_wqkv, A_wo, B_x, B_w1, B_w2, gate_w):
    def _A_ref(x, wqkv, wo):
        B, S, D = x.shape
        H = 32; Dh = D // H
        qkv = (lambda x, *d: x.permute(*d))((x @ wqkv).reshape(B, S, 3, H, Dh), 2, 0, 3, 1, 4)
        q, k, v = qkv[0], qkv[1], qkv[2]
        phi = lambda t: torch.where(t > 0, t + 1, torch.exp(t)) + 1e-6
        pq, pk = phi(q), phi(k)
        kv = torch.einsum("bhsd,bhse->bhde", pk, v)
        z = torch.einsum("bhsd->bhd", pk)
        num = torch.einsum("bhqd,bhde->bhqe", pq, kv)
        den = torch.einsum("bhqd,bhd->bhq", pq, z)[..., None] + 1e-6
        o = num / den
        return (lambda x, *d: x.permute(*d))(o, 0, 2, 1, 3).reshape(B, S, D) @ wo

    def _B_ref(x, w1, w2):
        h = torch.einsum("bsd,df->bsf", x, w1)
        h = _silu(h)
        out = torch.einsum("bsf,fd->bsd", h, w2)
        return out

    x = A_x
    g = _sigmoid((x * gate_w).sum(-1, keepdims=True))
    a = _A_ref(x, A_wqkv, A_wo)
    b = _B_ref(x, B_w1, B_w2)
    return g * a + (1 - g) * b
```

```asm
; @launch grid=(256,1,1) block=(512,1,1) lds=163840
.amdgcn_target "amdgcn-amd-amdhsa--gfx950"
.text
.globl gated_mix__linear_attn_block__dense_activation_silu__prompt_kernel
.p2align 8
.type gated_mix__linear_attn_block__dense_activation_silu__prompt_kernel,@function
gated_mix__linear_attn_block__dense_activation_silu__prompt_kernel:
L_code_start:
    s_cmp_ge_u32 s2, 256
    s_cbranch_scc1 L_end
    s_load_dwordx16 s[36:51], s[0:1], 0
    s_load_dwordx4 s[52:55], s[0:1], 64
    s_getpc_b64 s[34:35]
    v_lshlrev_b32 v1, 7, v0
    v_cmp_gt_u32 vcc, L_code_end-L_code_start-128, v1
    s_and_saveexec_b64 s[32:33], vcc
    s_cbranch_execz L_nocpf
    global_load_dword v249, v1, s[34:35]
L_nocpf:
    s_mov_b64 exec, s[32:33]
    v_lshrrev_b32 v1, 6, v0
    v_and_b32 v254, 63, v0
    s_and_b32 s64, s2, 7
    v_readfirstlane_b32 s56, v1
    s_lshr_b32 s65, s2, 3
    s_and_b32 s66, s65, 3
    s_lshr_b32 s57, s64, 1
    s_lshl_b32 s57, s57, 2
    s_add_u32 s57, s57, s66
    s_lshl_b32 s60, s64, 2
    s_add_u32 s60, s60, s66
    s_and_b32 s58, s64, 1
    s_lshr_b32 s59, s65, 2
    s_xor_b32 s61, s59, 4
    s_lshl_b32 s3, s66, 1
    s_and_b32 s3, s3, 7
    s_cmp_lg_u32 s59, 3
    s_cmov_b32 s3, 0
    s_cmp_eq_u32 s58, 1
    s_cmov_b32 s3, 0
    s_cmp_lt_u32 s56, 4
    s_cbranch_scc1 L_compute
    s_sub_u32 s68, s56, 4
    s_cmp_eq_u32 s58, 1
    s_movk_i32 s69, 3072
    s_cmov_b32 s69, 2752
    s_movk_i32 s65, 1024
    s_cmov_b32 s65, 128
    s_mov_b32 s33, 0
    s_mov_b32 s32, -1
    s_mov_b64 s[100:101], -1
    s_lshl_b32 s72, s59, 7
    s_add_u32 s71, s72, 1024
    s_cmp_eq_u32 s58, 0
    s_cbranch_scc1 L_h_go
    s_mul_i32 s71, s59, 384
    s_add_u32 s72, s71, 256
    s_cmp_lg_u32 s59, 7
    s_cbranch_scc1 L_h_go
    s_mov_b32 s32, 0
    s_mov_b32 s33, 1
    s_mov_b32 s100, 0x00ff00ff
    s_mov_b32 s101, 0xff00ff00
L_h_go:
    v_lshrrev_b32 v1, 3, v254
    v_and_b32 v2, 7, v254
    v_lshrrev_b32 v3, 4, v254
    v_xor_b32 v4, v2, v3
    v_lshlrev_b32 v5, 10, v1
    v_lshl_add_u32 v200, v4, 4, v5
    v_xor_b32 v6, 64, v200
    v_add_u32 v201, 7168, v6
    v_add_u32 v202, 14336, v200
    v_add_u32 v203, 21504, v6
    v_and_b32 v4, 15, v254
    v_lshlrev_b32 v5, 2, v3
    v_xor_b32 v4, v4, v5
    v_lshrrev_b32 v5, 3, v4
    v_mul_lo_u32 v5, s65, v5
    v_and_b32 v4, 7, v4
    v_lshl_add_u32 v4, v4, 4, v5
    s_lshl_b32 s64, s68, 3
    v_add_u32 v5, s64, v3
    v_mul_u32_u24 v5, s69, v5
    v_add_u32 v208, v4, v5
    s_lshl_b32 s64, s69, 2
    s_sub_u32 s64, s64, 1024
    v_add_u32 v209, s64, v208
    s_lshl_b32 s70, s57, 17
    s_lshl_b32 s64, s68, 15
    s_add_u32 s70, s70, s64
    s_lshl_b32 s74, s69, 6
    s_lshl_b32 s77, s69, 5
    s_lshl_b32 s75, s68, 12
    s_lshl_b32 s76, s68, 11
    s_lshl_b32 s79, s3, 7
    s_mul_i32 s73, s3, s74
    s_mov_b32 s67, s73
    s_lshl_b32 s66, s74, 3
    s_waitcnt lgkmcnt(0)
    s_load_dword s62, s[54:55], 0
    s_mov_b32 s4, s36
    s_mov_b32 s5, s37
    s_mov_b32 s6, 2097152
    s_mov_b32 s7, 0x20000
    s_cmp_eq_u32 s58, 1
    s_cselect_b64 s[8:9], s[44:45], s[38:39]
    s_mov_b32 s10, 1572864
    s_cmov_b32 s10, 1409024
    s_mov_b32 s11, 0x20000
    s_add_u32 m0, s75, 0
    s_add_u32 s64, s70, s79
    buffer_load_dwordx4 v200, s[4:7], s64 offen offset:0 lds
    buffer_load_dwordx4 v201, s[4:7], s64 offen offset:1024 lds
    buffer_load_dwordx4 v202, s[4:7], s64 offen offset:2048 lds
    buffer_load_dwordx4 v203, s[4:7], s64 offen offset:3072 lds
    s_add_u32 s79, s79, 128
    s_and_b32 s79, s79, 1023
    s_mov_b64 exec, s[100:101]
    s_add_u32 m0, s76, 131072
    s_add_u32 s64, s71, s73
    buffer_load_dwordx4 v208, s[8:11], s64 offen lds
    buffer_load_dwordx4 v209, s[8:11], s64 offen offset:1024 lds
    s_mov_b64 exec, -1
    s_add_u32 s73, s73, s77
    s_cmp_eq_u32 s73, s66
    s_cselect_b32 s73, 0, s73
    s_mov_b32 s12, s46
    s_mov_b32 s13, s47
    s_mov_b32 s14, 1409024
    s_mov_b32 s15, 0x20000
    s_mov_b32 s16, s40
    s_mov_b32 s17, s41
    s_mov_b32 s18, 524288
    s_mov_b32 s19, 0x20000
    s_mov_b32 s20, s54
    s_mov_b32 s21, s55
    s_mov_b32 s22, 12582912
    s_mov_b32 s23, 0x20000
    s_mov_b32 s24, s50
    s_mov_b32 s25, s51
    s_mov_b32 s26, 2097152
    s_mov_b32 s27, 0x20000
    s_mov_b64 s[96:97], s[8:9]
    s_and_b32 s98, s10, s32
    s_mov_b32 s99, 0x20000
    v_lshrrev_b32 v1, 3, v254
    v_and_b32 v2, 7, v254
    v_bfe_u32 v3, v254, 4, 1
    v_lshlrev_b32 v3, 2, v3
    v_xor_b32 v4, v2, v3
    v_lshlrev_b32 v4, 4, v4
    s_lshl_b32 s34, s68, 4
    v_add_u32 v1, s34, v1
    v_mul_u32_u24 v6, s69, v1
    v_add_u32 v204, v6, v4
    s_lshl_b32 s34, s69, 3
    s_sub_u32 s34, s34, 1024
    v_add_u32 v205, s34, v204
    s_cmp_eq_u32 s33, 0
    s_cbranch_scc1 L_h_nogate0
    s_mov_b32 s28, s48
    s_mov_b32 s29, s49
    s_mov_b32 s30, 1024
    s_mov_b32 s31, 0x20000
    v_lshlrev_b32 v1, 1, v2
    s_lshl_b32 s34, s68, 4
    buffer_load_ushort v160, v1, s[28:31], s34 offen offset:0
    buffer_load_ushort v161, v1, s[28:31], s34 offen offset:64
    buffer_load_ushort v162, v1, s[28:31], s34 offen offset:128
    buffer_load_ushort v163, v1, s[28:31], s34 offen offset:192
    buffer_load_ushort v164, v1, s[28:31], s34 offen offset:256
    buffer_load_ushort v165, v1, s[28:31], s34 offen offset:320
    buffer_load_ushort v166, v1, s[28:31], s34 offen offset:384
    buffer_load_ushort v167, v1, s[28:31], s34 offen offset:448
    buffer_load_ushort v168, v1, s[28:31], s34 offen offset:512
    buffer_load_ushort v169, v1, s[28:31], s34 offen offset:576
    buffer_load_ushort v170, v1, s[28:31], s34 offen offset:640
    buffer_load_ushort v171, v1, s[28:31], s34 offen offset:704
    buffer_load_ushort v172, v1, s[28:31], s34 offen offset:768
    buffer_load_ushort v173, v1, s[28:31], s34 offen offset:832
    buffer_load_ushort v174, v1, s[28:31], s34 offen offset:896
    buffer_load_ushort v175, v1, s[28:31], s34 offen offset:960
    s_lshl_b32 s34, s68, 11
    s_add_u32 s34, s34, 131072
    v_and_b32 v3, 3, v254
    v_xor_b32 v3, 2, v3
    v_lshlrev_b32 v3, 6, v3
    v_lshl_add_u32 v3, v2, 8, v3
    v_add_u32 v176, s34, v3
    v_xor_b32 v177, 64, v176
L_h_nogate0:
    s_lshr_b32 s34, s2, 3
    s_and_b32 s35, s2, 7
    s_cmp_eq_u32 s68, 0
    s_cbranch_scc1 L_pfx
    s_lshr_b32 s35, s35, 1
    s_lshl_b32 s35, s35, 5
    s_add_u32 s34, s34, s35
    s_mul_i32 s34, s34, 3
    s_add_u32 s34, s34, s68
    s_sub_u32 s34, s34, 1
    s_lshl_b32 s34, s34, 9
    s_mul_i32 s35, s74, 2
    s_add_u32 s0, s34, s35
    s_mov_b32 s1, s74
    v_min_u32 v206, 3, v254
    v_lshlrev_b32 v206, 7, v206
    s_mov_b64 s[28:29], s[8:9]
    s_mov_b32 s30, s10
    s_branch L_pfgo
L_pfx:
    s_lshl_b32 s35, s35, 18
    s_lshl_b32 s34, s34, 13
    s_add_u32 s0, s34, s35
    s_add_u32 s0, s0, 256
    s_movk_i32 s1, 128
    v_and_b32 v206, 7, v254
    v_lshlrev_b32 v206, 10, v206
    s_mov_b64 s[28:29], s[4:5]
    s_mov_b32 s30, 2097152
L_pfgo:
    s_mov_b32 s31, 0x20000
    v_lshrrev_b32 v250, 3, v254
    v_and_b32 v251, 7, v254
    v_bfe_u32 v252, v254, 4, 1
    v_lshlrev_b32 v252, 2, v252
    v_xor_b32 v251, v251, v252
    v_lshlrev_b32 v251, 4, v251
    s_and_b32 s35, s56, 3
    s_lshl_b32 s34, s35, 4
    v_add_u32 v250, s34, v250
    v_lshl_add_u32 v220, v250, 10, v251
    v_add_u32 v221, 7168, v220
    s_lshl_b32 s78, s61, 7
    buffer_load_dword v249, v206, s[28:31], s0 offen
    s_add_u32 s0, s0, s1
    buffer_load_dword v249, v206, s[28:31], s0 offen
    s_add_u32 s0, s0, s1
    buffer_load_dword v249, v206, s[28:31], s0 offen
    s_add_u32 s0, s0, s1
    buffer_load_dword v249, v206, s[28:31], s0 offen
    s_add_u32 s0, s0, s1
    buffer_load_dword v249, v206, s[28:31], s0 offen
    s_add_u32 s0, s0, s1
    buffer_load_dword v249, v206, s[28:31], s0 offen
    s_add_u32 s0, s0, s1
    v_and_b32 v248, 1, v254
    s_lshl_b32 s34, s2, 3
    s_lshl_b32 s35, s68, 1
    s_add_u32 s34, s34, s35
    v_lshlrev_b32 v248, 10, v248
    s_cmp_ge_u32 s34, 1376
    s_cbranch_scc1 L_pfg_1
    s_lshl_b32 s34, s34, 10
    buffer_load_dword v249, v248, s[12:15], s34 offen offset:384
    s_branch L_pfh_2
L_pfg_1:
    s_sub_u32 s34, s34, 1376
    s_lshl_b32 s34, s34, 10
    buffer_load_dword v249, v248, s[16:19], s34 offen offset:384
L_pfh_2:
    s_mov_b64 exec, s[100:101]
    s_add_u32 m0, s76, 139264
    s_add_u32 s64, s71, s73
    buffer_load_dwordx4 v208, s[8:11], s64 offen lds
    buffer_load_dwordx4 v209, s[8:11], s64 offen offset:1024 lds
    s_mov_b64 exec, -1
    s_add_u32 s73, s73, s77
    s_cmp_eq_u32 s73, s66
    s_cselect_b32 s73, 0, s73
    s_add_u32 m0, s75, 16384
    s_add_u32 s64, s70, s79
    buffer_load_dwordx4 v200, s[4:7], s64 offen offset:0 lds
    buffer_load_dwordx4 v201, s[4:7], s64 offen offset:1024 lds
    buffer_load_dwordx4 v202, s[4:7], s64 offen offset:2048 lds
    buffer_load_dwordx4 v203, s[4:7], s64 offen offset:3072 lds
    s_add_u32 s79, s79, 128
    s_and_b32 s79, s79, 1023
    s_mov_b64 exec, s[100:101]
    s_add_u32 m0, s76, 147456
    s_add_u32 s64, s71, s73
    buffer_load_dwordx4 v208, s[8:11], s64 offen lds
    buffer_load_dwordx4 v209, s[8:11], s64 offen offset:1024 lds
    s_mov_b64 exec, -1
    s_add_u32 s73, s73, s77
    s_cmp_eq_u32 s73, s66
    s_cselect_b32 s73, 0, s73
    s_mov_b64 exec, s[100:101]
    s_add_u32 m0, s76, 155648
    s_add_u32 s64, s71, s73
    buffer_load_dwordx4 v208, s[8:11], s64 offen lds
    buffer_load_dwordx4 v209, s[8:11], s64 offen offset:1024 lds
    s_mov_b64 exec, -1
    s_add_u32 s73, s73, s77
    s_cmp_eq_u32 s73, s66
    s_cselect_b32 s73, 0, s73
    s_waitcnt vmcnt(17)
    s_cmp_eq_u32 s33, 0
    s_cbranch_scc1 L_h_nogate_3
    s_waitcnt vmcnt(17)
    s_mov_b64 exec, 0xff
    ds_write_b16 v176, v160 offset:0
    ds_write_b16 v177, v160 offset:0
    ds_write_b16 v176, v161 offset:8192
    ds_write_b16 v177, v161 offset:8192
    ds_write_b16 v176, v162 offset:16384
    ds_write_b16 v177, v162 offset:16384
    ds_write_b16 v176, v163 offset:24576
    ds_write_b16 v177, v163 offset:24576
    s_mov_b64 exec, -1
L_h_nogate_3:
    s_waitcnt lgkmcnt(0)
    s_mul_i32 s62, s62, 0x9E3779B1
    s_add_u32 s62, s62, 0x7F4A7C15
    s_mov_b32 s63, 0x80000
    s_barrier
    v_and_b32 v248, 7, v254
    v_lshlrev_b32 v248, 7, v248
    s_lshl_b32 s34, s2, 13
    s_lshl_b32 s35, s68, 11
    s_add_u32 s34, s34, s35
    s_cmp_ge_u32 s2, 172
    s_cbranch_scc1 L_pfe_4
    buffer_load_dword v249, v248, s[12:15], s34 offen offset:0
    s_branch L_pff_5
L_pfe_4:
    s_sub_u32 s34, s34, 1409024
    buffer_load_dword v249, v248, s[16:19], s34 offen offset:0
L_pff_5:
    v_and_b32 v248, 7, v254
    v_lshlrev_b32 v248, 7, v248
    s_lshl_b32 s34, s2, 13
    s_lshl_b32 s35, s68, 11
    s_add_u32 s34, s34, s35
    s_cmp_ge_u32 s2, 172
    s_cbranch_scc1 L_pfe_6
    buffer_load_dword v249, v248, s[12:15], s34 offen offset:1024
    s_branch L_pff_7
L_pfe_6:
    s_sub_u32 s34, s34, 1409024
    buffer_load_dword v249, v248, s[16:19], s34 offen offset:1024
L_pff_7:
    s_add_u32 m0, s75, 32768
    s_add_u32 s64, s70, s79
    buffer_load_dwordx4 v200, s[4:7], s64 offen offset:0 lds
    buffer_load_dwordx4 v201, s[4:7], s64 offen offset:1024 lds
    buffer_load_dwordx4 v202, s[4:7], s64 offen offset:2048 lds
    buffer_load_dwordx4 v203, s[4:7], s64 offen offset:3072 lds
    s_add_u32 s79, s79, 128
    s_and_b32 s79, s79, 1023
    s_waitcnt vmcnt(14)
    s_waitcnt lgkmcnt(0)
    s_barrier
    s_mov_b64 exec, s[100:101]
    s_add_u32 m0, s76, 131072
    s_add_u32 s64, s71, s73
    buffer_load_dwordx4 v208, s[8:11], s64 offen lds
    buffer_load_dwordx4 v209, s[8:11], s64 offen offset:1024 lds
    s_mov_b64 exec, -1
    s_add_u32 s73, s73, s77
    s_cmp_eq_u32 s73, s66
    s_cselect_b32 s73, 0, s73
    s_cmp_eq_u32 s33, 0
    s_cbranch_scc1 L_h_nogate_8
    s_mov_b64 exec, 0xff
    ds_write_b16 v176, v164 offset:0
    ds_write_b16 v177, v164 offset:0
    s_mov_b64 exec, -1
L_h_nogate_8:
    v_and_b32 v1, 31, v254
    v_lshrrev_b32 v2, 5, v254
    v_lshlrev_b32 v3, 2, v2
    v_sub_u32 v3, v1, v3
    v_subrev_u32 v4, 4, v3
    v_cmp_gt_u32 vcc, 8, v3
    s_nop 1
    v_cndmask_b32 v4, v4, v3, vcc
    v_and_b32 v5, 4, v3
    v_cmp_eq_u32 vcc, 0, v5
    v_cmp_gt_u32 s[34:35], 12, v3
    s_and_b64 vcc, vcc, s[34:35]
    v_mov_b32 v5, 64
    s_nop 0
    v_cndmask_b32 v4, v5, v4, vcc
    v_and_b32 v5, 1, v4
    v_lshlrev_b32 v5, 4, v5
    v_mov_b32 v6, 0x3f80
    v_lshlrev_b32 v5, v5, v6
    v_lshrrev_b32 v4, 1, v4
    v_cmp_eq_u32 vcc, 0, v4
    s_nop 1
    v_cndmask_b32 v112, 0, v5, vcc
    v_cmp_eq_u32 vcc, 1, v4
    s_nop 1
    v_cndmask_b32 v113, 0, v5, vcc
    v_cmp_eq_u32 vcc, 2, v4
    s_nop 1
    v_cndmask_b32 v114, 0, v5, vcc
    v_cmp_eq_u32 vcc, 3, v4
    s_nop 1
    v_cndmask_b32 v115, 0, v5, vcc
    v_min_u32 v3, 16, v1
    v_lshl_add_u32 v3, v2, 5, v3
    v_lshlrev_b32 v116, 4, v3
    v_min_u32 v117, 15, v254
    v_lshlrev_b32 v117, 2, v117
    v_lshlrev_b32 v118, 4, v254
    s_lshr_b32 s34, s68, 1
    s_lshl_b32 s34, s34, 12
    s_and_b32 s35, s68, 1
    s_lshl_b32 s35, s35, 10
    s_add_u32 s34, s34, s35
    s_add_u32 s34, s34, 0
    v_add_u32 v118, s34, v118
    s_cmp_gt_u32 s59, 3
    s_cselect_b32 s34, 21, 22
    s_add_u32 s34, s34, s59
    s_cmp_eq_u32 s59, 3
    s_cmov_b32 s34, 29
    v_lshrrev_b32 v3, 3, v254
    v_lshl_add_u32 v3, s34, 3, v3
    v_add_u32 v4, 4, v3
    v_mul_u32_u24 v4, 9363, v4
    v_lshrrev_b32 v4, 16, v4
    v_add_u32 v3, v3, v4
    v_and_b32 v4, 7, v254
    v_lshlrev_b32 v4, 4, v4
    v_lshl_add_u32 v119, v3, 7, v4
    s_lshl_b32 s40, s59, 2
    s_add_u32 s40, s40, s68
    s_lshl_b32 s41, s40, 8
    s_add_u32 s41, s41, 24576
    s_lshl_b32 s40, s40, 14
    s_add_u32 s40, s40, 131072
    s_lshl_b32 s42, s57, 4
    s_add_u32 s42, s42, s68
    s_mul_i32 s42, s42, 35840
    s_add_u32 s42, s42, 1048576
    s_lshl_b32 s43, s57, 2
    s_add_u32 s43, s43, s68
    s_lshl_b32 s43, s43, 8
    s_lshl_b32 s44, s59, 2
    s_add_u32 s43, s43, s44
    s_add_u32 s43, s43, 32768
    s_mov_b32 s44, 0x358637bd
    v_lshrrev_b32 v250, 5, v254
    v_bfe_u32 v251, v254, 2, 2
    v_lshl_add_u32 v250, v250, 2, v251
    v_lshlrev_b32 v250, 7, v250
    v_lshrrev_b32 v251, 1, v251
    v_lshl_add_u32 v250, v251, 6, v250
    v_bfe_u32 v251, v254, 4, 1
    v_lshl_add_u32 v250, v251, 5, v250
    v_and_b32 v251, 3, v254
    v_lshl_add_u32 v250, v251, 3, v250
    s_and_b32 s35, s56, 3
    s_lshl_b32 s35, s35, 11
    v_add_u32 v216, s35, v250
    v_xor_b32 v217, 64, v216
    s_and_b32 s50, s56, 3
    s_lshr_b32 s51, s56, 2
    v_min_u32 v218, 7, v254
    v_lshlrev_b32 v218, 2, v218
    v_min_u32 v219, 7, v254
    v_lshlrev_b32 v219, 2, v219
    v_add_u32 v219, 0, v219
    s_lshl_b32 s34, s56, 2
    s_add_u32 s34, s34, 0
    v_mov_b32 v238, s34
    v_and_b32 v222, 31, v254
    v_lshlrev_b32 v222, 2, v222
    s_lshl_b32 s34, s60, 1
    s_add_u32 s34, s34, s51
    s_lshl_b32 s47, s34, 8
    s_lshl_b32 s34, s34, 2
    s_add_u32 s34, s34, s50
    s_mul_i32 s48, s34, 35840
    s_add_u32 s48, s48, 1048576
    s_lshr_b32 s35, s50, 1
    s_lshl_b32 s34, s35, 14
    s_add_u32 s47, s47, s34
    s_add_u32 s47, s47, 65536
    s_lshl_b32 s46, s60, 1
    s_add_u32 s46, s46, s35
    s_lshl_b32 s46, s46, 8
    s_add_u32 s46, s46, 655360
    s_add_u32 s52, s46, 0x4000
    s_add_u32 s53, s46, 0x8000
    s_lshr_b32 s49, s60, 1
    s_lshl_b32 s49, s49, 2
    s_add_u32 s49, s49, s50
    s_lshl_b32 s49, s49, 8
    s_add_u32 s49, s49, 32768
    v_lshrrev_b32 v1, 3, v254
    v_add_u32 v1, 0, v1
    v_add_u32 v2, 4, v1
    v_mul_u32_u24 v2, 9363, v2
    v_lshrrev_b32 v2, 16, v2
    v_add_u32 v1, v1, v2
    v_and_b32 v2, 7, v254
    v_lshlrev_b32 v2, 4, v2
    v_lshl_add_u32 v226, v1, 7, v2
    v_lshrrev_b32 v1, 3, v254
    v_add_u32 v1, 8, v1
    v_add_u32 v2, 4, v1
    v_mul_u32_u24 v2, 9363, v2
    v_lshrrev_b32 v2, 16, v2
    v_add_u32 v1, v1, v2
    v_and_b32 v2, 7, v254
    v_lshlrev_b32 v2, 4, v2
    v_lshl_add_u32 v227, v1, 7, v2
    v_lshrrev_b32 v1, 3, v254
    v_add_u32 v1, 16, v1
    v_add_u32 v2, 4, v1
    v_mul_u32_u24 v2, 9363, v2
    v_lshrrev_b32 v2, 16, v2
    v_add_u32 v1, v1, v2
    v_and_b32 v2, 7, v254
    v_lshlrev_b32 v2, 4, v2
    v_lshl_add_u32 v228, v1, 7, v2
    v_lshrrev_b32 v1, 3, v254
    v_add_u32 v1, 24, v1
    v_add_u32 v2, 4, v1
    v_mul_u32_u24 v2, 9363, v2
    v_lshrrev_b32 v2, 16, v2
    v_add_u32 v1, v1, v2
    v_and_b32 v2, 7, v254
    v_lshlrev_b32 v2, 4, v2
    v_lshl_add_u32 v229, v1, 7, v2
    v_lshrrev_b32 v1, 3, v254
    v_add_u32 v1, 32, v1
    v_add_u32 v2, 4, v1
    v_mul_u32_u24 v2, 9363, v2
    v_lshrrev_b32 v2, 16, v2
    v_add_u32 v1, v1, v2
    v_and_b32 v2, 7, v254
    v_lshlrev_b32 v2, 4, v2
    v_lshl_add_u32 v230, v1, 7, v2
    v_lshrrev_b32 v1, 3, v254
    v_add_u32 v1, 40, v1
    v_add_u32 v2, 4, v1
    v_mul_u32_u24 v2, 9363, v2
    v_lshrrev_b32 v2, 16, v2
    v_add_u32 v1, v1, v2
    v_and_b32 v2, 7, v254
    v_lshlrev_b32 v2, 4, v2
    v_lshl_add_u32 v231, v1, 7, v2
    v_lshrrev_b32 v1, 3, v254
    v_add_u32 v1, 48, v1
    v_add_u32 v2, 4, v1
    v_mul_u32_u24 v2, 9363, v2
    v_lshrrev_b32 v2, 16, v2
    v_add_u32 v1, v1, v2
    v_and_b32 v2, 7, v254
    v_lshlrev_b32 v2, 4, v2
    v_lshl_add_u32 v232, v1, 7, v2
    s_waitcnt vmcnt(10)
    s_waitcnt lgkmcnt(0)
    s_barrier
    s_mov_b64 exec, s[100:101]
    s_add_u32 m0, s76, 139264
    s_add_u32 s64, s71, s73
    buffer_load_dwordx4 v208, s[8:11], s64 offen lds
    buffer_load_dwordx4 v209, s[8:11], s64 offen offset:1024 lds
    s_mov_b64 exec, -1
    s_add_u32 s73, s73, s77
    s_cmp_eq_u32 s73, s66
    s_cselect_b32 s73, 0, s73
    s_cmp_eq_u32 s33, 0
    s_cbranch_scc1 L_h_nogate_9
    s_mov_b64 exec, 0xff
    ds_write_b16 v176, v165 offset:8192
    ds_write_b16 v177, v165 offset:8192
    s_mov_b64 exec, -1
L_h_nogate_9:
    s_add_u32 m0, s75, 49152
    s_add_u32 s64, s70, s79
    buffer_load_dwordx4 v200, s[4:7], s64 offen offset:0 lds
    buffer_load_dwordx4 v201, s[4:7], s64 offen offset:1024 lds
    buffer_load_dwordx4 v202, s[4:7], s64 offen offset:2048 lds
    buffer_load_dwordx4 v203, s[4:7], s64 offen offset:3072 lds
    s_add_u32 s79, s79, 128
    s_and_b32 s79, s79, 1023
    s_waitcnt vmcnt(14)
    s_waitcnt lgkmcnt(0)
    s_barrier
    s_mov_b64 exec, s[100:101]
    s_add_u32 m0, s76, 147456
    s_add_u32 s64, s71, s73
    buffer_load_dwordx4 v208, s[8:11], s64 offen lds
    buffer_load_dwordx4 v209, s[8:11], s64 offen offset:1024 lds
    s_mov_b64 exec, -1
    s_add_u32 s73, s73, s77
    s_cmp_eq_u32 s73, s66
    s_cselect_b32 s73, 0, s73
    s_cmp_eq_u32 s33, 0
    s_cbranch_scc1 L_h_nogate_10
    s_mov_b64 exec, 0xff
    ds_write_b16 v176, v166 offset:16384
    ds_write_b16 v177, v166 offset:16384
    s_mov_b64 exec, -1
L_h_nogate_10:
    s_waitcnt vmcnt(8)
    s_waitcnt lgkmcnt(0)
    s_barrier
    v_and_b32 v248, 3, v254
    s_lshr_b32 s34, s2, 3
    s_lshl_b32 s34, s34, 4
    s_lshl_b32 s35, s68, 2
    s_add_u32 s34, s34, s35
    s_add_u32 s34, s34, 0
    v_lshlrev_b32 v248, 10, v248
    s_cmp_ge_u32 s34, 1376
    s_cbranch_scc1 L_pfg_11
    s_lshl_b32 s34, s34, 10
    buffer_load_dword v249, v248, s[12:15], s34 offen offset:384
    s_branch L_pfh_12
L_pfg_11:
    s_sub_u32 s34, s34, 1376
    s_lshl_b32 s34, s34, 10
    buffer_load_dword v249, v248, s[16:19], s34 offen offset:384
L_pfh_12:
    s_mov_b64 exec, s[100:101]
    s_add_u32 m0, s76, 155648
    s_add_u32 s64, s71, s73
    buffer_load_dwordx4 v208, s[8:11], s64 offen lds
    buffer_load_dwordx4 v209, s[8:11], s64 offen offset:1024 lds
    s_mov_b64 exec, -1
    s_add_u32 s73, s73, s77
    s_cmp_eq_u32 s73, s66
    s_cselect_b32 s73, 0, s73
    s_cmp_eq_u32 s33, 0
    s_cbranch_scc1 L_h_nogate_13
    s_mov_b64 exec, 0xff
    ds_write_b16 v176, v167 offset:24576
    ds_write_b16 v177, v167 offset:24576
    s_mov_b64 exec, -1
L_h_nogate_13:
    s_add_u32 m0, s75, 65536
    s_add_u32 s64, s70, s79
    buffer_load_dwordx4 v200, s[4:7], s64 offen offset:0 lds
    buffer_load_dwordx4 v201, s[4:7], s64 offen offset:1024 lds
    buffer_load_dwordx4 v202, s[4:7], s64 offen offset:2048 lds
    buffer_load_dwordx4 v203, s[4:7], s64 offen offset:3072 lds
    s_add_u32 s79, s79, 128
    s_and_b32 s79, s79, 1023
    s_waitcnt vmcnt(13)
    s_waitcnt lgkmcnt(0)
    s_barrier
    s_mov_b64 exec, s[100:101]
    s_add_u32 m0, s76, 131072
    s_add_u32 s64, s71, s73
    buffer_load_dwordx4 v208, s[8:11], s64 offen lds
    buffer_load_dwordx4 v209, s[8:11], s64 offen offset:1024 lds
    s_mov_b64 exec, -1
    s_add_u32 s73, s73, s77
    s_cmp_eq_u32 s73, s66
    s_cselect_b32 s73, 0, s73
    s_cmp_eq_u32 s33, 0
    s_cbranch_scc1 L_h_nogate_14
    s_mov_b64 exec, 0xff
    ds_write_b16 v176, v168 offset:0
    ds_write_b16 v177, v168 offset:0
    s_mov_b64 exec, -1
L_h_nogate_14:
    s_waitcnt vmcnt(9)
    s_waitcnt lgkmcnt(0)
    s_barrier
    v_and_b32 v248, 3, v254
    s_lshr_b32 s34, s2, 3
    s_lshl_b32 s34, s34, 4
    s_lshl_b32 s35, s68, 2
    s_add_u32 s34, s34, s35
    s_add_u32 s34, s34, 512
    v_lshlrev_b32 v248, 10, v248
    s_cmp_ge_u32 s34, 1376
    s_cbranch_scc1 L_pfg_15
    s_lshl_b32 s34, s34, 10
    buffer_load_dword v249, v248, s[12:15], s34 offen offset:384
    s_branch L_pfh_16
L_pfg_15:
    s_sub_u32 s34, s34, 1376
    s_lshl_b32 s34, s34, 10
    buffer_load_dword v249, v248, s[16:19], s34 offen offset:384
L_pfh_16:
    s_mov_b64 exec, s[100:101]
    s_add_u32 m0, s76, 139264
    s_add_u32 s64, s71, s73
    buffer_load_dwordx4 v208, s[8:11], s64 offen lds
    buffer_load_dwordx4 v209, s[8:11], s64 offen offset:1024 lds
    s_mov_b64 exec, -1
    s_add_u32 s73, s73, s77
    s_cmp_eq_u32 s73, s66
    s_cselect_b32 s73, 0, s73
    s_cmp_eq_u32 s33, 0
    s_cbranch_scc1 L_h_nogate_17
    s_mov_b64 exec, 0xff
    ds_write_b16 v176, v169 offset:8192
    ds_write_b16 v177, v169 offset:8192
    s_mov_b64 exec, -1
L_h_nogate_17:
    s_add_u32 m0, s75, 81920
    s_add_u32 s64, s70, s79
    buffer_load_dwordx4 v200, s[4:7], s64 offen offset:0 lds
    buffer_load_dwordx4 v201, s[4:7], s64 offen offset:1024 lds
    buffer_load_dwordx4 v202, s[4:7], s64 offen offset:2048 lds
    buffer_load_dwordx4 v203, s[4:7], s64 offen offset:3072 lds
    s_add_u32 s79, s79, 128
    s_and_b32 s79, s79, 1023
    s_waitcnt vmcnt(13)
    s_waitcnt lgkmcnt(0)
    s_barrier
    s_mov_b64 exec, s[100:101]
    s_add_u32 m0, s76, 147456
    s_add_u32 s64, s71, s73
    buffer_load_dwordx4 v208, s[8:11], s64 offen lds
    buffer_load_dwordx4 v209, s[8:11], s64 offen offset:1024 lds
    s_mov_b64 exec, -1
    s_add_u32 s73, s73, s77
    s_cmp_eq_u32 s73, s66
    s_cselect_b32 s73, 0, s73
    s_cmp_eq_u32 s33, 0
    s_cbranch_scc1 L_h_nogate_18
    s_mov_b64 exec, 0xff
    ds_write_b16 v176, v170 offset:16384
    ds_write_b16 v177, v170 offset:16384
    s_mov_b64 exec, -1
L_h_nogate_18:
    s_waitcnt vmcnt(9)
    s_waitcnt lgkmcnt(0)
    s_barrier
    v_and_b32 v248, 3, v254
    s_lshr_b32 s34, s2, 3
    s_lshl_b32 s34, s34, 4
    s_lshl_b32 s35, s68, 2
    s_add_u32 s34, s34, s35
    s_add_u32 s34, s34, 1024
    v_lshlrev_b32 v248, 10, v248
    s_cmp_ge_u32 s34, 1376
    s_cbranch_scc1 L_pfg_19
    s_lshl_b32 s34, s34, 10
    buffer_load_dword v249, v248, s[12:15], s34 offen offset:384
    s_branch L_pfh_20
L_pfg_19:
    s_sub_u32 s34, s34, 1376
    s_lshl_b32 s34, s34, 10
    buffer_load_dword v249, v248, s[16:19], s34 offen offset:384
L_pfh_20:
    s_mov_b64 exec, s[100:101]
    s_add_u32 m0, s76, 155648
    s_add_u32 s64, s71, s73
    buffer_load_dwordx4 v208, s[8:11], s64 offen lds
    buffer_load_dwordx4 v209, s[8:11], s64 offen offset:1024 lds
    s_mov_b64 exec, -1
    s_add_u32 s73, s73, s77
    s_cmp_eq_u32 s73, s66
    s_cselect_b32 s73, 0, s73
    s_cmp_eq_u32 s33, 0
    s_cbranch_scc1 L_h_nogate_21
    s_mov_b64 exec, 0xff
    ds_write_b16 v176, v171 offset:24576
    ds_write_b16 v177, v171 offset:24576
    s_mov_b64 exec, -1
L_h_nogate_21:
    s_add_u32 m0, s75, 98304
    s_add_u32 s64, s70, s79
    buffer_load_dwordx4 v200, s[4:7], s64 offen offset:0 lds
    buffer_load_dwordx4 v201, s[4:7], s64 offen offset:1024 lds
    buffer_load_dwordx4 v202, s[4:7], s64 offen offset:2048 lds
    buffer_load_dwordx4 v203, s[4:7], s64 offen offset:3072 lds
    s_add_u32 s79, s79, 128
    s_and_b32 s79, s79, 1023
    s_waitcnt vmcnt(13)
    s_waitcnt lgkmcnt(0)
    s_barrier
    s_mov_b64 exec, s[100:101]
    s_add_u32 m0, s76, 131072
    s_add_u32 s64, s71, s73
    buffer_load_dwordx4 v208, s[8:11], s64 offen lds
    buffer_load_dwordx4 v209, s[8:11], s64 offen offset:1024 lds
    s_mov_b64 exec, -1
    s_add_u32 s73, s73, s77
    s_cmp_eq_u32 s73, s66
    s_cselect_b32 s73, 0, s73
    s_cmp_eq_u32 s33, 0
    s_cbranch_scc1 L_h_nogate_22
    s_mov_b64 exec, 0xff
    ds_write_b16 v176, v172 offset:0
    ds_write_b16 v177, v172 offset:0
    s_mov_b64 exec, -1
L_h_nogate_22:
    s_waitcnt vmcnt(9)
    s_waitcnt lgkmcnt(0)
    s_barrier
    v_and_b32 v248, 3, v254
    s_lshr_b32 s34, s2, 3
    s_lshl_b32 s34, s34, 4
    s_lshl_b32 s35, s68, 2
    s_add_u32 s34, s34, s35
    s_add_u32 s34, s34, 1536
    v_lshlrev_b32 v248, 10, v248
    s_cmp_ge_u32 s34, 1376
    s_cbranch_scc1 L_pfg_23
    s_lshl_b32 s34, s34, 10
    buffer_load_dword v249, v248, s[12:15], s34 offen offset:384
    s_branch L_pfh_24
L_pfg_23:
    s_sub_u32 s34, s34, 1376
    s_lshl_b32 s34, s34, 10
    buffer_load_dword v249, v248, s[16:19], s34 offen offset:384
L_pfh_24:
    s_mov_b64 exec, s[100:101]
    s_add_u32 m0, s76, 139264
    s_add_u32 s64, s71, s73
    buffer_load_dwordx4 v208, s[8:11], s64 offen lds
    buffer_load_dwordx4 v209, s[8:11], s64 offen offset:1024 lds
    s_mov_b64 exec, -1
    s_add_u32 s73, s73, s77
    s_cmp_eq_u32 s73, s66
    s_cselect_b32 s73, 0, s73
    s_cmp_eq_u32 s33, 0
    s_cbranch_scc1 L_h_nogate_25
    s_mov_b64 exec, 0xff
    ds_write_b16 v176, v173 offset:8192
    ds_write_b16 v177, v173 offset:8192
    s_mov_b64 exec, -1
L_h_nogate_25:
    s_add_u32 m0, s75, 114688
    s_add_u32 s64, s70, s79
    buffer_load_dwordx4 v200, s[4:7], s64 offen offset:0 lds
    buffer_load_dwordx4 v201, s[4:7], s64 offen offset:1024 lds
    buffer_load_dwordx4 v202, s[4:7], s64 offen offset:2048 lds
    buffer_load_dwordx4 v203, s[4:7], s64 offen offset:3072 lds
    s_add_u32 s79, s79, 128
    s_and_b32 s79, s79, 1023
    s_waitcnt vmcnt(13)
    s_waitcnt lgkmcnt(0)
    s_barrier
    s_mov_b64 exec, s[100:101]
    s_add_u32 m0, s76, 147456
    s_add_u32 s64, s71, s73
    buffer_load_dwordx4 v208, s[8:11], s64 offen lds
    buffer_load_dwordx4 v209, s[8:11], s64 offen offset:1024 lds
    s_mov_b64 exec, -1
    s_add_u32 s73, s73, s77
    s_cmp_eq_u32 s73, s66
    s_cselect_b32 s73, 0, s73
    s_cmp_eq_u32 s33, 0
    s_cbranch_scc1 L_h_nogate_26
    s_mov_b64 exec, 0xff
    ds_write_b16 v176, v174 offset:16384
    ds_write_b16 v177, v174 offset:16384
    s_mov_b64 exec, -1
L_h_nogate_26:
    s_waitcnt vmcnt(9)
    s_waitcnt lgkmcnt(0)
    s_barrier
    s_mov_b64 exec, s[100:101]
    s_add_u32 m0, s76, 155648
    s_add_u32 s64, s71, s73
    buffer_load_dwordx4 v208, s[8:11], s64 offen lds
    buffer_load_dwordx4 v209, s[8:11], s64 offen offset:1024 lds
    s_mov_b64 exec, -1
    s_add_u32 s73, s73, s77
    s_cmp_eq_u32 s73, s66
    s_cselect_b32 s73, 0, s73
    s_cmp_eq_u32 s33, 0
    s_cbranch_scc1 L_h_nogate_27
    s_mov_b64 exec, 0xff
    ds_write_b16 v176, v175 offset:24576
    ds_write_b16 v177, v175 offset:24576
    s_mov_b64 exec, -1
L_h_nogate_27:
    s_waitcnt vmcnt(8)
    s_waitcnt lgkmcnt(0)
    s_barrier
    s_add_u32 m0, s76, 131072
    s_add_u32 s64, s72, s67
    buffer_load_dwordx4 v204, s[96:99], s64 offen lds
    buffer_load_dwordx4 v205, s[96:99], s64 offen offset:1024 lds
    s_add_u32 s67, s67, s74
    s_cmp_eq_u32 s67, s66
    s_cselect_b32 s67, 0, s67
    s_waitcnt vmcnt(4)
    s_waitcnt lgkmcnt(0)
    s_barrier
    s_add_u32 m0, s76, 139264
    s_add_u32 s64, s72, s67
    buffer_load_dwordx4 v204, s[96:99], s64 offen lds
    buffer_load_dwordx4 v205, s[96:99], s64 offen offset:1024 lds
    s_add_u32 s67, s67, s74
    s_cmp_eq_u32 s67, s66
    s_cselect_b32 s67, 0, s67
    s_waitcnt vmcnt(4)
    s_waitcnt lgkmcnt(0)
    s_barrier
    s_add_u32 m0, s76, 147456
    s_add_u32 s64, s72, s67
    buffer_load_dwordx4 v204, s[96:99], s64 offen lds
    buffer_load_dwordx4 v205, s[96:99], s64 offen offset:1024 lds
    s_add_u32 s67, s67, s74
    s_cmp_eq_u32 s67, s66
    s_cselect_b32 s67, 0, s67
    s_waitcnt vmcnt(4)
    s_barrier
    s_add_u32 m0, s76, 155648
    s_add_u32 s64, s72, s67
    buffer_load_dwordx4 v204, s[96:99], s64 offen lds
    buffer_load_dwordx4 v205, s[96:99], s64 offen offset:1024 lds
    s_add_u32 s67, s67, s74
    s_cmp_eq_u32 s67, s66
    s_cselect_b32 s67, 0, s67
    s_waitcnt vmcnt(4)
    s_barrier
    v_lshrrev_b32 v250, 3, v254
    v_and_b32 v251, 7, v254
    v_bfe_u32 v252, v254, 4, 1
    v_lshlrev_b32 v252, 2, v252
    v_xor_b32 v251, v251, v252
    v_lshlrev_b32 v251, 4, v251
    s_lshl_b32 s0, s56, 3
    v_add_u32 v250, s0, v250
    v_lshl_add_u32 v236, v250, 10, v251
    v_add_u32 v237, 0x8000, v236
    s_lshl_b32 s0, s56, 10
    s_lshl_b32 s1, s61, 7
    s_mov_b32 s33, 0
    s_add_u32 m0, s76, 131072
    s_add_u32 s64, s72, s67
    buffer_load_dwordx4 v204, s[96:99], s64 offen lds
    buffer_load_dwordx4 v205, s[96:99], s64 offen offset:1024 lds
    s_add_u32 s67, s67, s74
    s_cmp_eq_u32 s67, s66
    s_cselect_b32 s67, 0, s67
    s_waitcnt vmcnt(4)
    s_barrier
    s_add_u32 m0, s76, 139264
    s_add_u32 s64, s72, s67
    buffer_load_dwordx4 v204, s[96:99], s64 offen lds
    buffer_load_dwordx4 v205, s[96:99], s64 offen offset:1024 lds
    s_add_u32 s67, s67, s74
    s_cmp_eq_u32 s67, s66
    s_cselect_b32 s67, 0, s67
    s_add_u32 m0, s76, 16384
    s_add_u32 s64, s72, s67
    buffer_load_dwordx4 v204, s[96:99], s64 offen lds
    buffer_load_dwordx4 v205, s[96:99], s64 offen offset:1024 lds
    s_add_u32 s67, s67, s74
    s_cmp_eq_u32 s67, s66
    s_cselect_b32 s67, 0, s67
    s_add_u32 m0, s76, 24576
    s_add_u32 s64, s72, s67
    buffer_load_dwordx4 v204, s[96:99], s64 offen lds
    buffer_load_dwordx4 v205, s[96:99], s64 offen offset:1024 lds
    s_add_u32 s67, s67, s74
    s_cmp_eq_u32 s67, s66
    s_cselect_b32 s67, 0, s67
    s_waitcnt vmcnt(8)
    s_barrier
    s_cmp_eq_u32 s58, 0
    s_cbranch_scc1 L_h_attn
    s_add_u32 m0, s76, 32768
    s_add_u32 s64, s78, 0
    buffer_load_dwordx4 v220, s[12:15], s64 offen lds
    buffer_load_dwordx4 v221, s[12:15], s64 offen offset:1024 lds
    s_add_u32 m0, s76, 40960
    s_add_u32 s64, s78, 196608
    buffer_load_dwordx4 v220, s[12:15], s64 offen lds
    buffer_load_dwordx4 v221, s[12:15], s64 offen offset:1024 lds
    s_waitcnt vmcnt(4)
    s_barrier
    s_add_u32 m0, s76, 147456
    s_add_u32 s64, s78, 393216
    buffer_load_dwordx4 v220, s[12:15], s64 offen lds
    buffer_load_dwordx4 v221, s[12:15], s64 offen offset:1024 lds
    s_add_u32 m0, s76, 49152
    s_add_u32 s64, s78, 589824
    buffer_load_dwordx4 v220, s[12:15], s64 offen lds
    buffer_load_dwordx4 v221, s[12:15], s64 offen offset:1024 lds
    s_add_u32 m0, s76, 57344
    s_add_u32 s64, s78, 786432
    buffer_load_dwordx4 v220, s[12:15], s64 offen lds
    buffer_load_dwordx4 v221, s[12:15], s64 offen offset:1024 lds
    s_add_u32 m0, s76, 155648
    s_add_u32 s64, s78, 983040
    buffer_load_dwordx4 v220, s[12:15], s64 offen lds
    buffer_load_dwordx4 v221, s[12:15], s64 offen offset:1024 lds
    s_barrier
    s_add_u32 m0, s76, 65536
    s_add_u32 s64, s78, 1179648
    buffer_load_dwordx4 v220, s[12:15], s64 offen lds
    buffer_load_dwordx4 v221, s[12:15], s64 offen offset:1024 lds
    s_add_u32 m0, s76, 73728
    s_add_u32 s64, s78, 65536
    buffer_load_dwordx4 v220, s[12:15], s64 offen lds
    buffer_load_dwordx4 v221, s[12:15], s64 offen offset:1024 lds
    s_add_u32 m0, s76, 131072
    s_add_u32 s64, s78, 262144
    buffer_load_dwordx4 v220, s[12:15], s64 offen lds
    buffer_load_dwordx4 v221, s[12:15], s64 offen offset:1024 lds
    s_add_u32 m0, s76, 81920
    s_add_u32 s64, s78, 458752
    buffer_load_dwordx4 v220, s[12:15], s64 offen lds
    buffer_load_dwordx4 v221, s[12:15], s64 offen offset:1024 lds
    s_add_u32 m0, s76, 90112
    s_add_u32 s64, s78, 655360
    buffer_load_dwordx4 v220, s[12:15], s64 offen lds
    buffer_load_dwordx4 v221, s[12:15], s64 offen offset:1024 lds
    s_barrier
    s_add_u32 m0, s76, 139264
    s_add_u32 s64, s78, 851968
    buffer_load_dwordx4 v220, s[12:15], s64 offen lds
    buffer_load_dwordx4 v221, s[12:15], s64 offen offset:1024 lds
    s_add_u32 m0, s76, 98304
    s_add_u32 s64, s78, 1048576
    buffer_load_dwordx4 v220, s[12:15], s64 offen lds
    buffer_load_dwordx4 v221, s[12:15], s64 offen offset:1024 lds
    s_add_u32 m0, s76, 106496
    s_add_u32 s64, s78, 1245184
    buffer_load_dwordx4 v220, s[12:15], s64 offen lds
    buffer_load_dwordx4 v221, s[12:15], s64 offen offset:1024 lds
    s_add_u32 m0, s76, 16384
    s_add_u32 s64, s78, 131072
    buffer_load_dwordx4 v220, s[12:15], s64 offen lds
    buffer_load_dwordx4 v221, s[12:15], s64 offen offset:1024 lds
    s_add_u32 m0, s76, 114688
    s_add_u32 s64, s78, 327680
    buffer_load_dwordx4 v220, s[12:15], s64 offen lds
    buffer_load_dwordx4 v221, s[12:15], s64 offen offset:1024 lds
    s_add_u32 m0, s76, 122880
    s_add_u32 s64, s78, 524288
    buffer_load_dwordx4 v220, s[12:15], s64 offen lds
    buffer_load_dwordx4 v221, s[12:15], s64 offen offset:1024 lds
    s_add_u32 m0, s76, 24576
    s_add_u32 s64, s78, 720896
    buffer_load_dwordx4 v220, s[12:15], s64 offen lds
    buffer_load_dwordx4 v221, s[12:15], s64 offen offset:1024 lds
    s_waitcnt vmcnt(12)
    s_barrier
    ds_read_b64_tr_b16 v[120:121], v216 offset:32768
    ds_read_b64_tr_b16 v[122:123], v216 offset:33792
    ds_read_b64_tr_b16 v[124:125], v217 offset:32768
    ds_read_b64_tr_b16 v[126:127], v217 offset:33792
    ds_read_b64_tr_b16 v[128:129], v216 offset:40960
    ds_read_b64_tr_b16 v[130:131], v216 offset:41984
    ds_read_b64_tr_b16 v[132:133], v217 offset:40960
    ds_read_b64_tr_b16 v[134:135], v217 offset:41984
    s_waitcnt lgkmcnt(8)
    ds_read_b64_tr_b16 v[144:145], v216 offset:49152
    ds_read_b64_tr_b16 v[146:147], v216 offset:50176
    ds_read_b64_tr_b16 v[148:149], v217 offset:49152
    ds_read_b64_tr_b16 v[150:151], v217 offset:50176
    s_waitcnt lgkmcnt(8)
    ds_read_b64_tr_b16 v[152:153], v216 offset:57344
    ds_read_b64_tr_b16 v[154:155], v216 offset:58368
    ds_read_b64_tr_b16 v[156:157], v217 offset:57344
    ds_read_b64_tr_b16 v[158:159], v217 offset:58368
    s_waitcnt lgkmcnt(8)
    v_add_u32 v216, 65536, v216
    v_add_u32 v217, 65536, v217
    ds_read_b64_tr_b16 v[168:169], v216 offset:0
    ds_read_b64_tr_b16 v[170:171], v216 offset:1024
    ds_read_b64_tr_b16 v[172:173], v217 offset:0
    ds_read_b64_tr_b16 v[174:175], v217 offset:1024
    s_waitcnt lgkmcnt(8)
    ds_read_b64_tr_b16 v[176:177], v216 offset:8192
    ds_read_b64_tr_b16 v[178:179], v216 offset:9216
    ds_read_b64_tr_b16 v[180:181], v217 offset:8192
    ds_read_b64_tr_b16 v[182:183], v217 offset:9216
    s_waitcnt lgkmcnt(8)
    ds_read_b64_tr_b16 v[192:193], v216 offset:16384
    ds_read_b64_tr_b16 v[194:195], v216 offset:17408
    ds_read_b64_tr_b16 v[196:197], v217 offset:16384
    ds_read_b64_tr_b16 v[198:199], v217 offset:17408
    s_waitcnt lgkmcnt(8)
    ds_read_b64_tr_b16 v[200:201], v216 offset:24576
    ds_read_b64_tr_b16 v[202:203], v216 offset:25600
    ds_read_b64_tr_b16 v[204:205], v217 offset:24576
    ds_read_b64_tr_b16 v[206:207], v217 offset:25600
    s_waitcnt lgkmcnt(8)
    v_add_u32 v216, 65536, v216
    v_add_u32 v217, 65536, v217
    ds_read_b64_tr_b16 v[184:185], v216 offset:0
    ds_read_b64_tr_b16 v[186:187], v216 offset:1024
    ds_read_b64_tr_b16 v[188:189], v217 offset:0
    ds_read_b64_tr_b16 v[190:191], v217 offset:1024
    s_waitcnt lgkmcnt(8)
    ds_read_b64_tr_b16 v[208:209], v216 offset:8192
    ds_read_b64_tr_b16 v[210:211], v216 offset:9216
    ds_read_b64_tr_b16 v[212:213], v217 offset:8192
    ds_read_b64_tr_b16 v[214:215], v217 offset:9216
    s_waitcnt lgkmcnt(8)
    ds_read_b64_tr_b16 v[136:137], v216 offset:16384
    ds_read_b64_tr_b16 v[138:139], v216 offset:17408
    ds_read_b64_tr_b16 v[140:141], v217 offset:16384
    ds_read_b64_tr_b16 v[142:143], v217 offset:17408
    s_waitcnt lgkmcnt(8)
    ds_read_b64_tr_b16 v[160:161], v216 offset:24576
    ds_read_b64_tr_b16 v[162:163], v216 offset:25600
    ds_read_b64_tr_b16 v[164:165], v217 offset:24576
    ds_read_b64_tr_b16 v[166:167], v217 offset:25600
    s_waitcnt lgkmcnt(8)
    s_waitcnt lgkmcnt(0)
    buffer_load_dword v250, v218, s[20:23], s46 offen sc1
    s_waitcnt vmcnt(0)
    s_barrier
    s_add_u32 m0, s0, 32768
    s_add_u32 s35, s1, 917504
    buffer_load_dwordx4 v236, s[12:15], s35 offen lds
    s_add_u32 m0, s0, 40960
    s_add_u32 s35, s1, 1114112
    buffer_load_dwordx4 v236, s[12:15], s35 offen lds
    s_add_u32 m0, s0, 147456
    s_add_u32 s35, s1, 1310720
    buffer_load_dwordx4 v236, s[12:15], s35 offen lds
    s_branch L_phase2_f
L_h_attn:
    s_add_u32 m0, s76, 32768
    s_add_u32 s64, s78, 0
    buffer_load_dwordx4 v220, s[12:15], s64 offen lds
    buffer_load_dwordx4 v221, s[12:15], s64 offen offset:1024 lds
    s_add_u32 m0, s76, 40960
    s_add_u32 s64, s78, 196608
    buffer_load_dwordx4 v220, s[12:15], s64 offen lds
    buffer_load_dwordx4 v221, s[12:15], s64 offen offset:1024 lds
    s_add_u32 m0, s76, 147456
    s_add_u32 s64, s78, 393216
    buffer_load_dwordx4 v220, s[12:15], s64 offen lds
    buffer_load_dwordx4 v221, s[12:15], s64 offen offset:1024 lds
    s_waitcnt vmcnt(6)
    s_barrier
    s_add_u32 m0, s76, 49152
    s_add_u32 s64, s78, 589824
    buffer_load_dwordx4 v220, s[12:15], s64 offen lds
    buffer_load_dwordx4 v221, s[12:15], s64 offen offset:1024 lds
    s_add_u32 m0, s76, 57344
    s_add_u32 s64, s78, 786432
    buffer_load_dwordx4 v220, s[12:15], s64 offen lds
    buffer_load_dwordx4 v221, s[12:15], s64 offen offset:1024 lds
    s_add_u32 m0, s76, 155648
    s_add_u32 s64, s78, 983040
    buffer_load_dwordx4 v220, s[12:15], s64 offen lds
    buffer_load_dwordx4 v221, s[12:15], s64 offen offset:1024 lds
    s_barrier
    s_add_u32 m0, s76, 65536
    s_add_u32 s64, s78, 1179648
    buffer_load_dwordx4 v220, s[12:15], s64 offen lds
    buffer_load_dwordx4 v221, s[12:15], s64 offen offset:1024 lds
    s_add_u32 m0, s76, 73728
    s_add_u32 s64, s78, 65536
    buffer_load_dwordx4 v220, s[12:15], s64 offen lds
    buffer_load_dwordx4 v221, s[12:15], s64 offen offset:1024 lds
    s_add_u32 m0, s76, 131072
    s_add_u32 s64, s78, 262144
    buffer_load_dwordx4 v220, s[12:15], s64 offen lds
    buffer_load_dwordx4 v221, s[12:15], s64 offen offset:1024 lds
    s_add_u32 m0, s76, 81920
    s_add_u32 s64, s78, 458752
    buffer_load_dwordx4 v220, s[12:15], s64 offen lds
    buffer_load_dwordx4 v221, s[12:15], s64 offen offset:1024 lds
    s_add_u32 m0, s76, 90112
    s_add_u32 s64, s78, 655360
    buffer_load_dwordx4 v220, s[12:15], s64 offen lds
    buffer_load_dwordx4 v221, s[12:15], s64 offen offset:1024 lds
    s_add_u32 m0, s76, 139264
    s_add_u32 s64, s78, 851968
    buffer_load_dwordx4 v220, s[12:15], s64 offen lds
    buffer_load_dwordx4 v221, s[12:15], s64 offen offset:1024 lds
    s_barrier
    s_add_u32 m0, s76, 98304
    s_add_u32 s64, s78, 1048576
    buffer_load_dwordx4 v220, s[12:15], s64 offen lds
    buffer_load_dwordx4 v221, s[12:15], s64 offen offset:1024 lds
    s_add_u32 m0, s76, 106496
    s_add_u32 s64, s78, 1245184
    buffer_load_dwordx4 v220, s[12:15], s64 offen lds
    buffer_load_dwordx4 v221, s[12:15], s64 offen offset:1024 lds
    s_waitcnt vmcnt(4)
    s_barrier
    s_add_u32 m0, s76, 16384
    s_add_u32 s64, s78, 131072
    buffer_load_dwordx4 v220, s[12:15], s64 offen lds
    buffer_load_dwordx4 v221, s[12:15], s64 offen offset:1024 lds
    s_add_u32 m0, s76, 114688
    s_add_u32 s64, s78, 327680
    buffer_load_dwordx4 v220, s[12:15], s64 offen lds
    buffer_load_dwordx4 v221, s[12:15], s64 offen offset:1024 lds
    s_add_u32 m0, s76, 122880
    s_add_u32 s64, s78, 524288
    buffer_load_dwordx4 v220, s[12:15], s64 offen lds
    buffer_load_dwordx4 v221, s[12:15], s64 offen offset:1024 lds
    s_add_u32 m0, s76, 24576
    s_add_u32 s64, s78, 720896
    buffer_load_dwordx4 v220, s[12:15], s64 offen lds
    buffer_load_dwordx4 v221, s[12:15], s64 offen offset:1024 lds
    ds_read_b64_tr_b16 v[120:121], v216 offset:32768
    ds_read_b64_tr_b16 v[122:123], v216 offset:33792
    ds_read_b64_tr_b16 v[124:125], v217 offset:32768
    ds_read_b64_tr_b16 v[126:127], v217 offset:33792
    ds_read_b64_tr_b16 v[128:129], v216 offset:40960
    ds_read_b64_tr_b16 v[130:131], v216 offset:41984
    ds_read_b64_tr_b16 v[132:133], v217 offset:40960
    ds_read_b64_tr_b16 v[134:135], v217 offset:41984
    s_waitcnt lgkmcnt(8)
    ds_read_b64_tr_b16 v[144:145], v216 offset:49152
    ds_read_b64_tr_b16 v[146:147], v216 offset:50176
    ds_read_b64_tr_b16 v[148:149], v217 offset:49152
    ds_read_b64_tr_b16 v[150:151], v217 offset:50176
    s_waitcnt lgkmcnt(8)
    ds_read_b64_tr_b16 v[152:153], v216 offset:57344
    ds_read_b64_tr_b16 v[154:155], v216 offset:58368
    ds_read_b64_tr_b16 v[156:157], v217 offset:57344
    ds_read_b64_tr_b16 v[158:159], v217 offset:58368
    s_waitcnt lgkmcnt(8)
    v_add_u32 v216, 65536, v216
    v_add_u32 v217, 65536, v217
    ds_read_b64_tr_b16 v[168:169], v216 offset:0
    ds_read_b64_tr_b16 v[170:171], v216 offset:1024
    ds_read_b64_tr_b16 v[172:173], v217 offset:0
    ds_read_b64_tr_b16 v[174:175], v217 offset:1024
    s_waitcnt lgkmcnt(8)
    ds_read_b64_tr_b16 v[176:177], v216 offset:8192
    ds_read_b64_tr_b16 v[178:179], v216 offset:9216
    ds_read_b64_tr_b16 v[180:181], v217 offset:8192
    ds_read_b64_tr_b16 v[182:183], v217 offset:9216
    s_waitcnt lgkmcnt(8)
    ds_read_b64_tr_b16 v[192:193], v216 offset:16384
    ds_read_b64_tr_b16 v[194:195], v216 offset:17408
    ds_read_b64_tr_b16 v[196:197], v217 offset:16384
    ds_read_b64_tr_b16 v[198:199], v217 offset:17408
    s_waitcnt lgkmcnt(8)
    ds_read_b64_tr_b16 v[200:201], v216 offset:24576
    ds_read_b64_tr_b16 v[202:203], v216 offset:25600
    ds_read_b64_tr_b16 v[204:205], v217 offset:24576
    ds_read_b64_tr_b16 v[206:207], v217 offset:25600
    s_waitcnt lgkmcnt(8)
    v_add_u32 v216, 65536, v216
    v_add_u32 v217, 65536, v217
    ds_read_b64_tr_b16 v[184:185], v216 offset:0
    ds_read_b64_tr_b16 v[186:187], v216 offset:1024
    ds_read_b64_tr_b16 v[188:189], v217 offset:0
    ds_read_b64_tr_b16 v[190:191], v217 offset:1024
    s_waitcnt lgkmcnt(8)
    ds_read_b64_tr_b16 v[208:209], v216 offset:8192
    ds_read_b64_tr_b16 v[210:211], v216 offset:9216
    ds_read_b64_tr_b16 v[212:213], v217 offset:8192
    ds_read_b64_tr_b16 v[214:215], v217 offset:9216
    s_waitcnt lgkmcnt(8)
    ds_read_b64_tr_b16 v[136:137], v216 offset:16384
    ds_read_b64_tr_b16 v[138:139], v216 offset:17408
    ds_read_b64_tr_b16 v[140:141], v217 offset:16384
    ds_read_b64_tr_b16 v[142:143], v217 offset:17408
    s_waitcnt lgkmcnt(8)
    ds_read_b64_tr_b16 v[160:161], v216 offset:24576
    ds_read_b64_tr_b16 v[162:163], v216 offset:25600
    ds_read_b64_tr_b16 v[164:165], v217 offset:24576
    ds_read_b64_tr_b16 v[166:167], v217 offset:25600
    s_waitcnt lgkmcnt(8)
    s_waitcnt lgkmcnt(0)
L_poll_28:
    buffer_load_dword v255, v117, s[20:23], s41 offen sc1
    s_waitcnt vmcnt(0)
    v_cmp_ne_u32 vcc, s62, v255
    s_cbranch_vccz L_polled_29
    s_sub_u32 s63, s63, 1
    s_cbranch_scc1 L_polled_29
    s_sleep 1
    s_branch L_poll_28
L_polled_29:
    buffer_load_dword v250, v218, s[20:23], s46 offen sc1
    s_mov_b32 exec_lo, 0x0011ffff
    s_mov_b32 exec_hi, 0x0011ffff
    buffer_load_dwordx4 v[32:35], v116, s[20:23], s40 offen offset:0 sc1
    buffer_load_dwordx4 v[36:39], v116, s[20:23], s40 offen offset:1024 sc1
    buffer_load_dwordx4 v[40:43], v116, s[20:23], s40 offen offset:2048 sc1
    buffer_load_dwordx4 v[44:47], v116, s[20:23], s40 offen offset:3072 sc1
    s_add_u32 s40, s40, 4096
    buffer_load_dwordx4 v[48:51], v116, s[20:23], s40 offen offset:0 sc1
    buffer_load_dwordx4 v[52:55], v116, s[20:23], s40 offen offset:1024 sc1
    buffer_load_dwordx4 v[56:59], v116, s[20:23], s40 offen offset:2048 sc1
    buffer_load_dwordx4 v[60:63], v116, s[20:23], s40 offen offset:3072 sc1
    s_add_u32 s40, s40, 4096
    buffer_load_dwordx4 v[64:67], v116, s[20:23], s40 offen offset:0 sc1
    buffer_load_dwordx4 v[68:71], v116, s[20:23], s40 offen offset:1024 sc1
    buffer_load_dwordx4 v[72:75], v116, s[20:23], s40 offen offset:2048 sc1
    buffer_load_dwordx4 v[76:79], v116, s[20:23], s40 offen offset:3072 sc1
    s_add_u32 s40, s40, 4096
    buffer_load_dwordx4 v[80:83], v116, s[20:23], s40 offen offset:0 sc1
    buffer_load_dwordx4 v[84:87], v116, s[20:23], s40 offen offset:1024 sc1
    buffer_load_dwordx4 v[88:91], v116, s[20:23], s40 offen offset:2048 sc1
    buffer_load_dwordx4 v[92:95], v116, s[20:23], s40 offen offset:3072 sc1
    s_mov_b64 exec, -1
    s_mov_b32 s33, s43
    s_barrier
    ds_read_b128 v[96:99], v118 offset:0
    ds_read_b128 v[100:103], v118 offset:2048
    ds_read_b128 v[104:107], v118 offset:8192
    ds_read_b128 v[108:111], v118 offset:10240
    s_waitcnt vmcnt(15)
    v_mfma_f32_32x32x16_bf16 v[0:15], v[112:115], v[32:35], 0
    s_waitcnt vmcnt(14)
    v_mfma_f32_32x32x16_bf16 v[0:15], v[112:115], v[36:39], v[0:15]
    s_waitcnt vmcnt(13)
    v_mfma_f32_32x32x16_bf16 v[0:15], v[112:115], v[40:43], v[0:15]
    s_waitcnt vmcnt(12)
    v_mfma_f32_32x32x16_bf16 v[0:15], v[112:115], v[44:47], v[0:15]
    s_waitcnt vmcnt(11)
    v_mfma_f32_32x32x16_bf16 v[0:15], v[112:115], v[48:51], v[0:15]
    s_waitcnt vmcnt(10)
    v_mfma_f32_32x32x16_bf16 v[0:15], v[112:115], v[52:55], v[0:15]
    s_waitcnt vmcnt(9)
    v_mfma_f32_32x32x16_bf16 v[0:15], v[112:115], v[56:59], v[0:15]
    s_waitcnt vmcnt(8)
    v_mfma_f32_32x32x16_bf16 v[0:15], v[112:115], v[60:63], v[0:15]
    s_waitcnt vmcnt(7)
    v_mfma_f32_32x32x16_bf16 v[0:15], v[112:115], v[64:67], v[0:15]
    s_waitcnt vmcnt(6)
    v_mfma_f32_32x32x16_bf16 v[0:15], v[112:115], v[68:71], v[0:15]
    s_waitcnt vmcnt(5)
    v_mfma_f32_32x32x16_bf16 v[0:15], v[112:115], v[72:75], v[0:15]
    s_waitcnt vmcnt(4)
    v_mfma_f32_32x32x16_bf16 v[0:15], v[112:115], v[76:79], v[0:15]
    s_waitcnt vmcnt(3)
    v_mfma_f32_32x32x16_bf16 v[0:15], v[112:115], v[80:83], v[0:15]
    s_waitcnt vmcnt(2)
    v_mfma_f32_32x32x16_bf16 v[0:15], v[112:115], v[84:87], v[0:15]
    s_waitcnt vmcnt(1)
    v_mfma_f32_32x32x16_bf16 v[0:15], v[112:115], v[88:91], v[0:15]
    s_waitcnt vmcnt(0)
    v_mfma_f32_32x32x16_bf16 v[0:15], v[112:115], v[92:95], v[0:15]
    s_nop 11
    v_cvt_pk_bf16_f32 v16, v0, v1
    v_cvt_pk_bf16_f32 v17, v2, v3
    v_cvt_pk_bf16_f32 v18, v4, v5
    v_cvt_pk_bf16_f32 v19, v6, v7
    s_waitcnt lgkmcnt(0)
    s_nop 0
    v_mfma_f32_32x32x16_bf16 v[32:47], v[16:19], v[96:99], 0
    v_mfma_f32_32x32x16_bf16 v[48:63], v[16:19], v[100:103], 0
    v_mfma_f32_32x32x16_bf16 v[64:79], v[16:19], v[104:107], 0
    v_mfma_f32_32x32x16_bf16 v[80:95], v[16:19], v[108:111], 0
    s_nop 8
    v_add_f32 v40, s44, v40
    v_rcp_f32 v40, v40
    s_nop 0
    v_pk_mul_f32 v[32:33], v[32:33], v[40:41] op_sel_hi:[1,0]
    v_pk_mul_f32 v[34:35], v[34:35], v[40:41] op_sel_hi:[1,0]
    v_pk_mul_f32 v[36:37], v[36:37], v[40:41] op_sel_hi:[1,0]
    v_pk_mul_f32 v[38:39], v[38:39], v[40:41] op_sel_hi:[1,0]
    v_cvt_pk_bf16_f32 v44, v32, v33
    v_cvt_pk_bf16_f32 v45, v34, v35
    v_cvt_pk_bf16_f32 v46, v36, v37
    v_cvt_pk_bf16_f32 v47, v38, v39
    buffer_store_dwordx4 v[44:47], v119, s[20:23], s42 offen sc1
    s_add_u32 s42, s42, 143360
    v_add_f32 v56, s44, v56
    v_rcp_f32 v56, v56
    s_nop 0
    v_pk_mul_f32 v[48:49], v[48:49], v[56:57] op_sel_hi:[1,0]
    v_pk_mul_f32 v[50:51], v[50:51], v[56:57] op_sel_hi:[1,0]
    v_pk_mul_f32 v[52:53], v[52:53], v[56:57] op_sel_hi:[1,0]
    v_pk_mul_f32 v[54:55], v[54:55], v[56:57] op_sel_hi:[1,0]
    v_cvt_pk_bf16_f32 v60, v48, v49
    v_cvt_pk_bf16_f32 v61, v50, v51
    v_cvt_pk_bf16_f32 v62, v52, v53
    v_cvt_pk_bf16_f32 v63, v54, v55
    buffer_store_dwordx4 v[60:63], v119, s[20:23], s42 offen sc1
    s_add_u32 s42, s42, 143360
    v_add_f32 v72, s44, v72
    v_rcp_f32 v72, v72
    s_nop 0
    v_pk_mul_f32 v[64:65], v[64:65], v[72:73] op_sel_hi:[1,0]
    v_pk_mul_f32 v[66:67], v[66:67], v[72:73] op_sel_hi:[1,0]
    v_pk_mul_f32 v[68:69], v[68:69], v[72:73] op_sel_hi:[1,0]
    v_pk_mul_f32 v[70:71], v[70:71], v[72:73] op_sel_hi:[1,0]
    v_cvt_pk_bf16_f32 v76, v64, v65
    v_cvt_pk_bf16_f32 v77, v66, v67
    v_cvt_pk_bf16_f32 v78, v68, v69
    v_cvt_pk_bf16_f32 v79, v70, v71
    buffer_store_dwordx4 v[76:79], v119, s[20:23], s42 offen sc1
    s_add_u32 s42, s42, 143360
    v_add_f32 v88, s44, v88
    v_rcp_f32 v88, v88
    s_nop 0
    v_pk_mul_f32 v[80:81], v[80:81], v[88:89] op_sel_hi:[1,0]
    v_pk_mul_f32 v[82:83], v[82:83], v[88:89] op_sel_hi:[1,0]
    v_pk_mul_f32 v[84:85], v[84:85], v[88:89] op_sel_hi:[1,0]
    v_pk_mul_f32 v[86:87], v[86:87], v[88:89] op_sel_hi:[1,0]
    v_cvt_pk_bf16_f32 v92, v80, v81
    v_cvt_pk_bf16_f32 v93, v82, v83
    v_cvt_pk_bf16_f32 v94, v84, v85
    v_cvt_pk_bf16_f32 v95, v86, v87
    buffer_store_dwordx4 v[92:95], v119, s[20:23], s42 offen sc1
    s_add_u32 s42, s42, 143360
    s_barrier
    s_branch L_phase2_a
L_compute:
    s_lshr_b32 s68, s56, 1
    s_and_b32 s69, s56, 1
    v_and_b32 v1, 31, v254
    v_lshrrev_b32 v2, 5, v254
    v_bfe_u32 v3, v254, 1, 3
    v_xor_b32 v3, v2, v3
    s_lshl_b32 s64, s68, 6
    v_add_u32 v1, s64, v1
    v_lshlrev_b32 v1, 7, v1
    v_lshl_add_u32 v144, v3, 4, v1
    v_xor_b32 v145, 32, v144
    v_xor_b32 v146, 64, v144
    v_xor_b32 v147, 96, v144
    v_add_u32 v148, 0x10000, v144
    v_add_u32 v149, 0x10000, v145
    v_add_u32 v150, 0x10000, v146
    v_add_u32 v151, 0x10000, v147
    v_bfe_u32 v3, v254, 2, 2
    v_lshl_add_u32 v4, v2, 3, v3
    v_bfe_u32 v5, v254, 4, 1
    v_lshlrev_b32 v5, 5, v5
    v_and_b32 v6, 3, v254
    v_lshl_add_u32 v5, v6, 3, v5
    v_add_u32 v5, 131072, v5
    v_lshl_add_u32 v6, v4, 8, v5
    v_xor_b32 v7, s69, v3
    v_lshl_add_u32 v152, v7, 6, v6
    v_xor_b32 v153, 128, v152
    v_lshl_add_u32 v6, v4, 7, v5
    v_lshrrev_b32 v3, 1, v3
    v_xor_b32 v3, s69, v3
    v_lshl_add_u32 v154, v3, 6, v6
    v_subrev_u32 v155, 131072, v154
    s_waitcnt lgkmcnt(0)
    s_load_dword s62, s[54:55], 0
    s_mov_b32 s12, s46
    s_mov_b32 s13, s47
    s_mov_b32 s14, 1409024
    s_mov_b32 s15, 0x20000
    s_mov_b32 s16, s40
    s_mov_b32 s17, s41
    s_mov_b32 s18, 524288
    s_mov_b32 s19, 0x20000
    s_mov_b32 s20, s54
    s_mov_b32 s21, s55
    s_mov_b32 s22, 12582912
    s_mov_b32 s23, 0x20000
    s_mov_b32 s24, s50
    s_mov_b32 s25, s51
    s_mov_b32 s26, 2097152
    s_mov_b32 s27, 0x20000
    s_cmp_lg_u32 s56, 0
    s_cbranch_scc1 L_c_nopt
    v_min_u32 v1, 21, v254
    v_lshlrev_b32 v1, 7, v1
    s_mul_i32 s64, s2, 2816
    buffer_load_dword v249, v1, s[20:23], s64 offen sc1
L_c_nopt:
    v_lshrrev_b32 v250, 5, v254
    v_bfe_u32 v251, v254, 2, 2
    v_lshl_add_u32 v250, v250, 2, v251
    v_lshlrev_b32 v250, 7, v250
    v_lshrrev_b32 v251, 1, v251
    v_lshl_add_u32 v250, v251, 6, v250
    v_bfe_u32 v251, v254, 4, 1
    v_lshl_add_u32 v250, v251, 5, v250
    v_and_b32 v251, 3, v254
    v_lshl_add_u32 v250, v251, 3, v250
    s_and_b32 s35, s56, 3
    s_lshl_b32 s35, s35, 11
    v_add_u32 v216, s35, v250
    v_xor_b32 v217, 64, v216
    v_lshrrev_b32 v250, 3, v254
    v_and_b32 v251, 7, v254
    v_bfe_u32 v252, v254, 4, 1
    v_lshlrev_b32 v252, 2, v252
    v_xor_b32 v251, v251, v252
    v_lshlrev_b32 v251, 4, v251
    s_lshl_b32 s0, s56, 3
    v_add_u32 v250, s0, v250
    v_lshl_add_u32 v236, v250, 10, v251
    v_add_u32 v237, 0x8000, v236
    s_lshl_b32 s0, s56, 10
    s_lshl_b32 s1, s61, 7
    s_mov_b32 s33, 0
    s_cmp_eq_u32 s58, 1
    s_cbranch_scc1 L_c_setf
    s_mov_b32 s70, 0x3fb8aa3b
    s_mov_b32 s72, 0x358637bd
    s_mov_b32 s74, 0x0000ffff
    s_mov_b32 s75, 0x0000ffff
    s_lshl_b32 s64, s68, 4
    v_xor_b32 v233, s64, v254
    v_lshlrev_b32 v233, 4, v233
    v_lshlrev_b32 v234, 4, v254
    s_lshl_b32 s64, s56, 12
    s_add_u32 s64, s64, 0
    v_add_u32 v234, s64, v234
    v_xor_b32 v235, 8192, v234
    s_lshl_b32 s76, s59, 2
    s_lshl_b32 s77, s69, 1
    s_add_u32 s76, s76, s77
    s_add_u32 s76, s76, s68
    s_lshl_b32 s77, s76, 8
    s_lshl_b32 s78, s57, 2
    s_add_u32 s77, s77, s78
    s_add_u32 s77, s77, 24576
    s_lshl_b32 s76, s76, 4
    s_add_u32 s76, s76, s57
    s_lshl_b32 s76, s76, 10
    s_add_u32 s76, s76, 131072
    s_cmp_eq_u32 s68, 0
    s_mov_b32 s78, 0xffff0001
    s_cmov_b32 s78, 0x1ffff
    s_mov_b32 s79, s78
    s_cselect_b64 s[66:67], 0, -1
    s_branch L_c_set1
L_c_setf:
    s_mov_b32 s70, 0xbfb8aa3b
    s_lshl_b32 s64, s57, 2
    s_lshl_b32 s65, s68, 1
    s_add_u32 s64, s64, s65
    s_lshl_b32 s66, s64, 8
    s_lshl_b32 s64, s64, 2
    s_lshl_b32 s65, s69, 1
    s_add_u32 s64, s64, s65
    s_mul_i32 s64, s64, 35840
    s_add_u32 s72, s64, 1048576
    s_add_u32 s73, s72, 35840
    s_add_u32 s74, s72, 143360
    s_add_u32 s75, s73, 143360
    s_lshl_b32 s76, s69, 14
    s_add_u32 s76, s76, s66
    s_add_u32 s76, s76, 65536
    s_lshl_b32 s77, s57, 1
    s_add_u32 s77, s77, s68
    s_lshl_b32 s77, s77, 1
    s_add_u32 s77, s77, s69
    s_lshl_b32 s77, s77, 8
    s_lshl_b32 s66, s59, 2
    s_add_u32 s77, s77, s66
    s_add_u32 s77, s77, 655360
    s_mov_b32 s64, s59
    s_cmp_eq_u32 s59, 7
    s_cmov_b32 s64, 21
    s_cselect_b32 s66, 0x8000, 0
    s_add_u32 s77, s77, s66
    v_lshrrev_b32 v1, 3, v254
    v_lshl_add_u32 v1, s64, 3, v1
    v_add_u32 v2, 4, v1
    v_mul_u32_u24 v2, 9363, v2
    v_lshrrev_b32 v2, 16, v2
    v_add_u32 v1, v1, v2
    v_and_b32 v2, 7, v254
    v_lshlrev_b32 v2, 4, v2
    v_lshl_add_u32 v233, v1, 7, v2
    s_add_u32 s64, s64, 7
    v_lshrrev_b32 v1, 3, v254
    v_lshl_add_u32 v1, s64, 3, v1
    v_add_u32 v2, 4, v1
    v_mul_u32_u24 v2, 9363, v2
    v_lshrrev_b32 v2, 16, v2
    v_add_u32 v1, v1, v2
    v_and_b32 v2, 7, v254
    v_lshlrev_b32 v2, 4, v2
    v_lshl_add_u32 v234, v1, 7, v2
    s_add_u32 s64, s64, 7
    v_lshrrev_b32 v1, 3, v254
    v_lshl_add_u32 v1, s64, 3, v1
    v_add_u32 v2, 4, v1
    v_mul_u32_u24 v2, 9363, v2
    v_lshrrev_b32 v2, 16, v2
    v_add_u32 v1, v1, v2
    v_and_b32 v2, 7, v254
    v_lshlrev_b32 v2, 4, v2
    v_lshl_add_u32 v235, v1, 7, v2
    s_add_u32 s64, s64, 7
L_c_set1:
    s_and_b32 s50, s56, 3
    s_lshr_b32 s51, s56, 2
    v_min_u32 v218, 7, v254
    v_lshlrev_b32 v218, 2, v218
    v_min_u32 v219, 7, v254
    v_lshlrev_b32 v219, 2, v219
    v_add_u32 v219, 0, v219
    s_lshl_b32 s34, s56, 2
    s_add_u32 s34, s34, 0
    v_mov_b32 v238, s34
    v_and_b32 v222, 31, v254
    v_lshlrev_b32 v222, 2, v222
    s_lshl_b32 s34, s60, 1
    s_add_u32 s34, s34, s51
    s_lshl_b32 s47, s34, 8
    s_lshl_b32 s34, s34, 2
    s_add_u32 s34, s34, s50
    s_mul_i32 s48, s34, 35840
    s_add_u32 s48, s48, 1048576
    s_lshr_b32 s35, s50, 1
    s_lshl_b32 s34, s35, 14
    s_add_u32 s47, s47, s34
    s_add_u32 s47, s47, 65536
    s_lshl_b32 s46, s60, 1
    s_add_u32 s46, s46, s35
    s_lshl_b32 s46, s46, 8
    s_add_u32 s46, s46, 655360
    s_add_u32 s52, s46, 0x4000
    s_add_u32 s53, s46, 0x8000
    s_lshr_b32 s49, s60, 1
    s_lshl_b32 s49, s49, 2
    s_add_u32 s49, s49, s50
    s_lshl_b32 s49, s49, 8
    s_add_u32 s49, s49, 32768
    v_lshrrev_b32 v1, 3, v254
    v_add_u32 v1, 0, v1
    v_add_u32 v2, 4, v1
    v_mul_u32_u24 v2, 9363, v2
    v_lshrrev_b32 v2, 16, v2
    v_add_u32 v1, v1, v2
    v_and_b32 v2, 7, v254
    v_lshlrev_b32 v2, 4, v2
    v_lshl_add_u32 v226, v1, 7, v2
    v_lshrrev_b32 v1, 3, v254
    v_add_u32 v1, 8, v1
    v_add_u32 v2, 4, v1
    v_mul_u32_u24 v2, 9363, v2
    v_lshrrev_b32 v2, 16, v2
    v_add_u32 v1, v1, v2
    v_and_b32 v2, 7, v254
    v_lshlrev_b32 v2, 4, v2
    v_lshl_add_u32 v227, v1, 7, v2
    v_lshrrev_b32 v1, 3, v254
    v_add_u32 v1, 16, v1
    v_add_u32 v2, 4, v1
    v_mul_u32_u24 v2, 9363, v2
    v_lshrrev_b32 v2, 16, v2
    v_add_u32 v1, v1, v2
    v_and_b32 v2, 7, v254
    v_lshlrev_b32 v2, 4, v2
    v_lshl_add_u32 v228, v1, 7, v2
    v_lshrrev_b32 v1, 3, v254
    v_add_u32 v1, 24, v1
    v_add_u32 v2, 4, v1
    v_mul_u32_u24 v2, 9363, v2
    v_lshrrev_b32 v2, 16, v2
    v_add_u32 v1, v1, v2
    v_and_b32 v2, 7, v254
    v_lshlrev_b32 v2, 4, v2
    v_lshl_add_u32 v229, v1, 7, v2
    v_lshrrev_b32 v1, 3, v254
    v_add_u32 v1, 32, v1
    v_add_u32 v2, 4, v1
    v_mul_u32_u24 v2, 9363, v2
    v_lshrrev_b32 v2, 16, v2
    v_add_u32 v1, v1, v2
    v_and_b32 v2, 7, v254
    v_lshlrev_b32 v2, 4, v2
    v_lshl_add_u32 v230, v1, 7, v2
    v_lshrrev_b32 v1, 3, v254
    v_add_u32 v1, 40, v1
    v_add_u32 v2, 4, v1
    v_mul_u32_u24 v2, 9363, v2
    v_lshrrev_b32 v2, 16, v2
    v_add_u32 v1, v1, v2
    v_and_b32 v2, 7, v254
    v_lshlrev_b32 v2, 4, v2
    v_lshl_add_u32 v231, v1, 7, v2
    v_lshrrev_b32 v1, 3, v254
    v_add_u32 v1, 48, v1
    v_add_u32 v2, 4, v1
    v_mul_u32_u24 v2, 9363, v2
    v_lshrrev_b32 v2, 16, v2
    v_add_u32 v1, v1, v2
    v_and_b32 v2, 7, v254
    v_lshlrev_b32 v2, 4, v2
    v_lshl_add_u32 v232, v1, 7, v2
    s_waitcnt lgkmcnt(0)
    s_mul_i32 s62, s62, 0x9E3779B1
    s_add_u32 s62, s62, 0x7F4A7C15
    s_mov_b32 s63, 0x80000
    s_barrier
    s_cmp_eq_u32 s58, 1
    s_cbranch_scc1 L_c_ffn
    ds_read_b128 v[96:99], v144 offset:0
    ds_read_b64_tr_b16 v[104:105], v152 offset:0
    ds_read_b64_tr_b16 v[106:107], v152 offset:1024
    ds_read_b128 v[100:103], v144 offset:4096
    ds_read_b64_tr_b16 v[108:109], v153 offset:0
    ds_read_b64_tr_b16 v[110:111], v153 offset:1024
    ds_read_b128 v[112:115], v145 offset:0
    ds_read_b64_tr_b16 v[120:121], v152 offset:4096
    ds_read_b64_tr_b16 v[122:123], v152 offset:5120
    ds_read_b128 v[116:119], v145 offset:4096
    ds_read_b64_tr_b16 v[124:125], v153 offset:4096
    ds_read_b64_tr_b16 v[126:127], v153 offset:5120
    s_waitcnt lgkmcnt(9)
    v_mfma_f32_32x32x16_bf16 v[32:47], v[96:99], v[104:107], 0
    s_waitcnt lgkmcnt(0)
    s_barrier
    ds_read_b128 v[128:131], v146 offset:0
    ds_read_b64_tr_b16 v[136:137], v152 offset:8192
    v_mfma_f32_32x32x16_bf16 v[48:63], v[100:103], v[104:107], 0
    ds_read_b64_tr_b16 v[138:139], v152 offset:9216
    ds_read_b128 v[132:135], v146 offset:4096
    v_mfma_f32_32x32x16_bf16 v[64:79], v[96:99], v[108:111], 0
    ds_read_b64_tr_b16 v[140:141], v153 offset:8192
    ds_read_b64_tr_b16 v[142:143], v153 offset:9216
    v_mfma_f32_32x32x16_bf16 v[80:95], v[100:103], v[108:111], 0
    v_mfma_f32_32x32x16_bf16 v[32:47], v[112:115], v[120:123], v[32:47]
    ds_read_b128 v[96:99], v147 offset:0
    ds_read_b64_tr_b16 v[104:105], v152 offset:12288
    v_mfma_f32_32x32x16_bf16 v[48:63], v[116:119], v[120:123], v[48:63]
    ds_read_b64_tr_b16 v[106:107], v152 offset:13312
    ds_read_b128 v[100:103], v147 offset:4096
    v_mfma_f32_32x32x16_bf16 v[64:79], v[112:115], v[124:127], v[64:79]
    ds_read_b64_tr_b16 v[108:109], v153 offset:12288
    ds_read_b64_tr_b16 v[110:111], v153 offset:13312
    v_mfma_f32_32x32x16_bf16 v[80:95], v[116:119], v[124:127], v[80:95]
    s_waitcnt lgkmcnt(9)
    v_mfma_f32_32x32x16_bf16 v[32:47], v[128:131], v[136:139], v[32:47]
    s_waitcnt lgkmcnt(0)
    s_barrier
    ds_read_b128 v[112:115], v144 offset:16384
    ds_read_b64_tr_b16 v[120:121], v152 offset:16384
    v_mfma_f32_32x32x16_bf16 v[48:63], v[132:135], v[136:139], v[48:63]
    ds_read_b64_tr_b16 v[122:123], v152 offset:17408
    ds_read_b128 v[116:119], v144 offset:20480
    v_mfma_f32_32x32x16_bf16 v[64:79], v[128:131], v[140:143], v[64:79]
    ds_read_b64_tr_b16 v[124:125], v153 offset:16384
    ds_read_b64_tr_b16 v[126:127], v153 offset:17408
    v_mfma_f32_32x32x16_bf16 v[80:95], v[132:135], v[140:143], v[80:95]
    v_mfma_f32_32x32x16_bf16 v[32:47], v[96:99], v[104:107], v[32:47]
    ds_read_b128 v[128:131], v145 offset:16384
    ds_read_b64_tr_b16 v[136:137], v152 offset:20480
    v_mfma_f32_32x32x16_bf16 v[48:63], v[100:103], v[104:107], v[48:63]
    ds_read_b64_tr_b16 v[138:139], v152 offset:21504
    ds_read_b128 v[132:135], v145 offset:20480
    v_mfma_f32_32x32x16_bf16 v[64:79], v[96:99], v[108:111], v[64:79]
    ds_read_b64_tr_b16 v[140:141], v153 offset:20480
    ds_read_b64_tr_b16 v[142:143], v153 offset:21504
    v_mfma_f32_32x32x16_bf16 v[80:95], v[100:103], v[108:111], v[80:95]
    s_waitcnt lgkmcnt(9)
    v_mfma_f32_32x32x16_bf16 v[32:47], v[112:115], v[120:123], v[32:47]
    s_waitcnt lgkmcnt(0)
    s_barrier
    ds_read_b128 v[96:99], v146 offset:16384
    ds_read_b64_tr_b16 v[104:105], v152 offset:24576
    v_mfma_f32_32x32x16_bf16 v[48:63], v[116:119], v[120:123], v[48:63]
    ds_read_b64_tr_b16 v[106:107], v152 offset:25600
    ds_read_b128 v[100:103], v146 offset:20480
    v_mfma_f32_32x32x16_bf16 v[64:79], v[112:115], v[124:127], v[64:79]
    ds_read_b64_tr_b16 v[108:109], v153 offset:24576
    ds_read_b64_tr_b16 v[110:111], v153 offset:25600
    v_mfma_f32_32x32x16_bf16 v[80:95], v[116:119], v[124:127], v[80:95]
    v_mfma_f32_32x32x16_bf16 v[32:47], v[128:131], v[136:139], v[32:47]
    ds_read_b128 v[112:115], v147 offset:16384
    ds_read_b64_tr_b16 v[120:121], v152 offset:28672
    v_mfma_f32_32x32x16_bf16 v[48:63], v[132:135], v[136:139], v[48:63]
    ds_read_b64_tr_b16 v[122:123], v152 offset:29696
    ds_read_b128 v[116:119], v147 offset:20480
    v_mfma_f32_32x32x16_bf16 v[64:79], v[128:131], v[140:143], v[64:79]
    ds_read_b64_tr_b16 v[124:125], v153 offset:28672
    ds_read_b64_tr_b16 v[126:127], v153 offset:29696
    v_mfma_f32_32x32x16_bf16 v[80:95], v[132:135], v[140:143], v[80:95]
    s_waitcnt lgkmcnt(9)
    v_mfma_f32_32x32x16_bf16 v[32:47], v[96:99], v[104:107], v[32:47]
    s_waitcnt lgkmcnt(0)
    s_barrier
    ds_read_b128 v[128:131], v144 offset:32768
    ds_read_b64_tr_b16 v[136:137], v152 offset:0
    v_mfma_f32_32x32x16_bf16 v[48:63], v[100:103], v[104:107], v[48:63]
    ds_read_b64_tr_b16 v[138:139], v152 offset:1024
    ds_read_b128 v[132:135], v144 offset:36864
    v_mfma_f32_32x32x16_bf16 v[64:79], v[96:99], v[108:111], v[64:79]
    ds_read_b64_tr_b16 v[140:141], v153 offset:0
    ds_read_b64_tr_b16 v[142:143], v153 offset:1024
    v_mfma_f32_32x32x16_bf16 v[80:95], v[100:103], v[108:111], v[80:95]
    v_mfma_f32_32x32x16_bf16 v[32:47], v[112:115], v[120:123], v[32:47]
    ds_read_b128 v[96:99], v145 offset:32768
    ds_read_b64_tr_b16 v[104:105], v152 offset:4096
    v_mfma_f32_32x32x16_bf16 v[48:63], v[116:119], v[120:123], v[48:63]
    ds_read_b64_tr_b16 v[106:107], v152 offset:5120
    ds_read_b128 v[100:103], v145 offset:36864
    v_mfma_f32_32x32x16_bf16 v[64:79], v[112:115], v[124:127], v[64:79]
    ds_read_b64_tr_b16 v[108:109], v153 offset:4096
    ds_read_b64_tr_b16 v[110:111], v153 offset:5120
    v_mfma_f32_32x32x16_bf16 v[80:95], v[116:119], v[124:127], v[80:95]
    s_waitcnt lgkmcnt(9)
    v_mfma_f32_32x32x16_bf16 v[32:47], v[128:131], v[136:139], v[32:47]
    s_waitcnt lgkmcnt(0)
    s_barrier
    ds_read_b128 v[112:115], v146 offset:32768
    ds_read_b64_tr_b16 v[120:121], v152 offset:8192
    v_mfma_f32_32x32x16_bf16 v[48:63], v[132:135], v[136:139], v[48:63]
    ds_read_b64_tr_b16 v[122:123], v152 offset:9216
    ds_read_b128 v[116:119], v146 offset:36864
    v_mfma_f32_32x32x16_bf16 v[64:79], v[128:131], v[140:143], v[64:79]
    ds_read_b64_tr_b16 v[124:125], v153 offset:8192
    ds_read_b64_tr_b16 v[126:127], v153 offset:9216
    v_mfma_f32_32x32x16_bf16 v[80:95], v[132:135], v[140:143], v[80:95]
    v_mfma_f32_32x32x16_bf16 v[32:47], v[96:99], v[104:107], v[32:47]
    ds_read_b128 v[128:131], v147 offset:32768
    ds_read_b64_tr_b16 v[136:137], v152 offset:12288
    v_mfma_f32_32x32x16_bf16 v[48:63], v[100:103], v[104:107], v[48:63]
    ds_read_b64_tr_b16 v[138:139], v152 offset:13312
    ds_read_b128 v[132:135], v147 offset:36864
    v_mfma_f32_32x32x16_bf16 v[64:79], v[96:99], v[108:111], v[64:79]
    ds_read_b64_tr_b16 v[140:141], v153 offset:12288
    ds_read_b64_tr_b16 v[142:143], v153 offset:13312
    v_mfma_f32_32x32x16_bf16 v[80:95], v[100:103], v[108:111], v[80:95]
    s_waitcnt lgkmcnt(9)
    v_mfma_f32_32x32x16_bf16 v[32:47], v[112:115], v[120:123], v[32:47]
    s_waitcnt lgkmcnt(0)
    s_barrier
    ds_read_b128 v[96:99], v144 offset:49152
    ds_read_b64_tr_b16 v[104:105], v152 offset:16384
    v_mfma_f32_32x32x16_bf16 v[48:63], v[116:119], v[120:123], v[48:63]
    ds_read_b64_tr_b16 v[106:107], v152 offset:17408
    ds_read_b128 v[100:103], v144 offset:53248
    v_mfma_f32_32x32x16_bf16 v[64:79], v[112:115], v[124:127], v[64:79]
    ds_read_b64_tr_b16 v[108:109], v153 offset:16384
    ds_read_b64_tr_b16 v[110:111], v153 offset:17408
    v_mfma_f32_32x32x16_bf16 v[80:95], v[116:119], v[124:127], v[80:95]
    v_mfma_f32_32x32x16_bf16 v[32:47], v[128:131], v[136:139], v[32:47]
    ds_read_b128 v[112:115], v145 offset:49152
    ds_read_b64_tr_b16 v[120:121], v152 offset:20480
    v_mfma_f32_32x32x16_bf16 v[48:63], v[132:135], v[136:139], v[48:63]
    ds_read_b64_tr_b16 v[122:123], v152 offset:21504
    ds_read_b128 v[116:119], v145 offset:53248
    v_mfma_f32_32x32x16_bf16 v[64:79], v[128:131], v[140:143], v[64:79]
    ds_read_b64_tr_b16 v[124:125], v153 offset:20480
    ds_read_b64_tr_b16 v[126:127], v153 offset:21504
    v_mfma_f32_32x32x16_bf16 v[80:95], v[132:135], v[140:143], v[80:95]
    s_waitcnt lgkmcnt(9)
    v_mfma_f32_32x32x16_bf16 v[32:47], v[96:99], v[104:107], v[32:47]
    s_waitcnt lgkmcnt(0)
    s_barrier
    ds_read_b128 v[128:131], v146 offset:49152
    ds_read_b64_tr_b16 v[136:137], v152 offset:24576
    v_mfma_f32_32x32x16_bf16 v[48:63], v[100:103], v[104:107], v[48:63]
    ds_read_b64_tr_b16 v[138:139], v152 offset:25600
    ds_read_b128 v[132:135], v146 offset:53248
    v_mfma_f32_32x32x16_bf16 v[64:79], v[96:99], v[108:111], v[64:79]
    ds_read_b64_tr_b16 v[140:141], v153 offset:24576
    ds_read_b64_tr_b16 v[142:143], v153 offset:25600
    v_mfma_f32_32x32x16_bf16 v[80:95], v[100:103], v[108:111], v[80:95]
    v_mfma_f32_32x32x16_bf16 v[32:47], v[112:115], v[120:123], v[32:47]
    ds_read_b128 v[96:99], v147 offset:49152
    ds_read_b64_tr_b16 v[104:105], v152 offset:28672
    v_mfma_f32_32x32x16_bf16 v[48:63], v[116:119], v[120:123], v[48:63]
    ds_read_b64_tr_b16 v[106:107], v152 offset:29696
    ds_read_b128 v[100:103], v147 offset:53248
    v_mfma_f32_32x32x16_bf16 v[64:79], v[112:115], v[124:127], v[64:79]
    ds_read_b64_tr_b16 v[108:109], v153 offset:28672
    ds_read_b64_tr_b16 v[110:111], v153 offset:29696
    v_mfma_f32_32x32x16_bf16 v[80:95], v[116:119], v[124:127], v[80:95]
    s_waitcnt lgkmcnt(9)
    v_mfma_f32_32x32x16_bf16 v[32:47], v[128:131], v[136:139], v[32:47]
    s_waitcnt lgkmcnt(0)
    s_barrier
    ds_read_b128 v[112:115], v148 offset:0
    ds_read_b64_tr_b16 v[120:121], v152 offset:0
    v_mfma_f32_32x32x16_bf16 v[48:63], v[132:135], v[136:139], v[48:63]
    ds_read_b64_tr_b16 v[122:123], v152 offset:1024
    ds_read_b128 v[116:119], v148 offset:4096
    v_mfma_f32_32x32x16_bf16 v[64:79], v[128:131], v[140:143], v[64:79]
    ds_read_b64_tr_b16 v[124:125], v153 offset:0
    ds_read_b64_tr_b16 v[126:127], v153 offset:1024
    v_mfma_f32_32x32x16_bf16 v[80:95], v[132:135], v[140:143], v[80:95]
    v_mfma_f32_32x32x16_bf16 v[32:47], v[96:99], v[104:107], v[32:47]
    ds_read_b128 v[128:131], v149 offset:0
    ds_read_b64_tr_b16 v[136:137], v152 offset:4096
    v_mfma_f32_32x32x16_bf16 v[48:63], v[100:103], v[104:107], v[48:63]
    ds_read_b64_tr_b16 v[138:139], v152 offset:5120
    ds_read_b128 v[132:135], v149 offset:4096
    v_mfma_f32_32x32x16_bf16 v[64:79], v[96:99], v[108:111], v[64:79]
    ds_read_b64_tr_b16 v[140:141], v153 offset:4096
    ds_read_b64_tr_b16 v[142:143], v153 offset:5120
    v_mfma_f32_32x32x16_bf16 v[80:95], v[100:103], v[108:111], v[80:95]
    s_waitcnt lgkmcnt(9)
    v_mfma_f32_32x32x16_bf16 v[32:47], v[112:115], v[120:123], v[32:47]
    s_waitcnt lgkmcnt(0)
    s_barrier
    ds_read_b128 v[96:99], v150 offset:0
    ds_read_b64_tr_b16 v[104:105], v152 offset:8192
    v_mfma_f32_32x32x16_bf16 v[48:63], v[116:119], v[120:123], v[48:63]
    ds_read_b64_tr_b16 v[106:107], v152 offset:9216
    ds_read_b128 v[100:103], v150 offset:4096
    v_mfma_f32_32x32x16_bf16 v[64:79], v[112:115], v[124:127], v[64:79]
    ds_read_b64_tr_b16 v[108:109], v153 offset:8192
    ds_read_b64_tr_b16 v[110:111], v153 offset:9216
    v_mfma_f32_32x32x16_bf16 v[80:95], v[116:119], v[124:127], v[80:95]
    v_mfma_f32_32x32x16_bf16 v[32:47], v[128:131], v[136:139], v[32:47]
    ds_read_b128 v[112:115], v151 offset:0
    ds_read_b64_tr_b16 v[120:121], v152 offset:12288
    v_mfma_f32_32x32x16_bf16 v[48:63], v[132:135], v[136:139], v[48:63]
    ds_read_b64_tr_b16 v[122:123], v152 offset:13312
    ds_read_b128 v[116:119], v151 offset:4096
    v_mfma_f32_32x32x16_bf16 v[64:79], v[128:131], v[140:143], v[64:79]
    ds_read_b64_tr_b16 v[124:125], v153 offset:12288
    ds_read_b64_tr_b16 v[126:127], v153 offset:13312
    v_mfma_f32_32x32x16_bf16 v[80:95], v[132:135], v[140:143], v[80:95]
    s_waitcnt lgkmcnt(9)
    v_mfma_f32_32x32x16_bf16 v[32:47], v[96:99], v[104:107], v[32:47]
    s_waitcnt lgkmcnt(0)
    s_barrier
    ds_read_b128 v[128:131], v148 offset:16384
    ds_read_b64_tr_b16 v[136:137], v152 offset:16384
    v_mfma_f32_32x32x16_bf16 v[48:63], v[100:103], v[104:107], v[48:63]
    ds_read_b64_tr_b16 v[138:139], v152 offset:17408
    ds_read_b128 v[132:135], v148 offset:20480
    v_mfma_f32_32x32x16_bf16 v[64:79], v[96:99], v[108:111], v[64:79]
    ds_read_b64_tr_b16 v[140:141], v153 offset:16384
    ds_read_b64_tr_b16 v[142:143], v153 offset:17408
    v_mfma_f32_32x32x16_bf16 v[80:95], v[100:103], v[108:111], v[80:95]
    v_mfma_f32_32x32x16_bf16 v[32:47], v[112:115], v[120:123], v[32:47]
    ds_read_b128 v[96:99], v149 offset:16384
    ds_read_b64_tr_b16 v[104:105], v152 offset:20480
    v_mfma_f32_32x32x16_bf16 v[48:63], v[116:119], v[120:123], v[48:63]
    ds_read_b64_tr_b16 v[106:107], v152 offset:21504
    ds_read_b128 v[100:103], v149 offset:20480
    v_mfma_f32_32x32x16_bf16 v[64:79], v[112:115], v[124:127], v[64:79]
    ds_read_b64_tr_b16 v[108:109], v153 offset:20480
    ds_read_b64_tr_b16 v[110:111], v153 offset:21504
    v_mfma_f32_32x32x16_bf16 v[80:95], v[116:119], v[124:127], v[80:95]
    s_waitcnt lgkmcnt(9)
    v_mfma_f32_32x32x16_bf16 v[32:47], v[128:131], v[136:139], v[32:47]
    s_waitcnt lgkmcnt(0)
    s_barrier
    ds_read_b128 v[112:115], v150 offset:16384
    ds_read_b64_tr_b16 v[120:121], v152 offset:24576
    v_mfma_f32_32x32x16_bf16 v[48:63], v[132:135], v[136:139], v[48:63]
    ds_read_b64_tr_b16 v[122:123], v152 offset:25600
    ds_read_b128 v[116:119], v150 offset:20480
    v_mfma_f32_32x32x16_bf16 v[64:79], v[128:131], v[140:143], v[64:79]
    ds_read_b64_tr_b16 v[124:125], v153 offset:24576
    ds_read_b64_tr_b16 v[126:127], v153 offset:25600
    v_mfma_f32_32x32x16_bf16 v[80:95], v[132:135], v[140:143], v[80:95]
    v_mfma_f32_32x32x16_bf16 v[32:47], v[96:99], v[104:107], v[32:47]
    ds_read_b128 v[128:131], v151 offset:16384
    ds_read_b64_tr_b16 v[136:137], v152 offset:28672
    v_mfma_f32_32x32x16_bf16 v[48:63], v[100:103], v[104:107], v[48:63]
    ds_read_b64_tr_b16 v[138:139], v152 offset:29696
    ds_read_b128 v[132:135], v151 offset:20480
    v_mfma_f32_32x32x16_bf16 v[64:79], v[96:99], v[108:111], v[64:79]
    ds_read_b64_tr_b16 v[140:141], v153 offset:28672
    ds_read_b64_tr_b16 v[142:143], v153 offset:29696
    v_mfma_f32_32x32x16_bf16 v[80:95], v[100:103], v[108:111], v[80:95]
    s_waitcnt lgkmcnt(9)
    v_mfma_f32_32x32x16_bf16 v[32:47], v[112:115], v[120:123], v[32:47]
    s_waitcnt lgkmcnt(0)
    s_barrier
    ds_read_b128 v[96:99], v148 offset:32768
    ds_read_b64_tr_b16 v[104:105], v152 offset:0
    v_mfma_f32_32x32x16_bf16 v[48:63], v[116:119], v[120:123], v[48:63]
    ds_read_b64_tr_b16 v[106:107], v152 offset:1024
    ds_read_b128 v[100:103], v148 offset:36864
    v_mfma_f32_32x32x16_bf16 v[64:79], v[112:115], v[124:127], v[64:79]
    ds_read_b64_tr_b16 v[108:109], v153 offset:0
    ds_read_b64_tr_b16 v[110:111], v153 offset:1024
    v_mfma_f32_32x32x16_bf16 v[80:95], v[116:119], v[124:127], v[80:95]
    v_mfma_f32_32x32x16_bf16 v[32:47], v[128:131], v[136:139], v[32:47]
    ds_read_b128 v[112:115], v149 offset:32768
    ds_read_b64_tr_b16 v[120:121], v152 offset:4096
    v_mfma_f32_32x32x16_bf16 v[48:63], v[132:135], v[136:139], v[48:63]
    ds_read_b64_tr_b16 v[122:123], v152 offset:5120
    ds_read_b128 v[116:119], v149 offset:36864
    v_mfma_f32_32x32x16_bf16 v[64:79], v[128:131], v[140:143], v[64:79]
    ds_read_b64_tr_b16 v[124:125], v153 offset:4096
    ds_read_b64_tr_b16 v[126:127], v153 offset:5120
    v_mfma_f32_32x32x16_bf16 v[80:95], v[132:135], v[140:143], v[80:95]
    s_waitcnt lgkmcnt(9)
    v_mfma_f32_32x32x16_bf16 v[32:47], v[96:99], v[104:107], v[32:47]
    s_waitcnt lgkmcnt(0)
    s_barrier
    ds_read_b128 v[128:131], v150 offset:32768
    ds_read_b64_tr_b16 v[136:137], v152 offset:8192
    v_mfma_f32_32x32x16_bf16 v[48:63], v[100:103], v[104:107], v[48:63]
    ds_read_b64_tr_b16 v[138:139], v152 offset:9216
    ds_read_b128 v[132:135], v150 offset:36864
    v_mfma_f32_32x32x16_bf16 v[64:79], v[96:99], v[108:111], v[64:79]
    ds_read_b64_tr_b16 v[140:141], v153 offset:8192
    ds_read_b64_tr_b16 v[142:143], v153 offset:9216
    v_mfma_f32_32x32x16_bf16 v[80:95], v[100:103], v[108:111], v[80:95]
    v_mfma_f32_32x32x16_bf16 v[32:47], v[112:115], v[120:123], v[32:47]
    ds_read_b128 v[96:99], v151 offset:32768
    ds_read_b64_tr_b16 v[104:105], v152 offset:12288
    v_mfma_f32_32x32x16_bf16 v[48:63], v[116:119], v[120:123], v[48:63]
    ds_read_b64_tr_b16 v[106:107], v152 offset:13312
    ds_read_b128 v[100:103], v151 offset:36864
    v_mfma_f32_32x32x16_bf16 v[64:79], v[112:115], v[124:127], v[64:79]
    ds_read_b64_tr_b16 v[108:109], v153 offset:12288
    ds_read_b64_tr_b16 v[110:111], v153 offset:13312
    v_mfma_f32_32x32x16_bf16 v[80:95], v[116:119], v[124:127], v[80:95]
    s_waitcnt lgkmcnt(9)
    v_mfma_f32_32x32x16_bf16 v[32:47], v[128:131], v[136:139], v[32:47]
    s_waitcnt lgkmcnt(0)
    s_barrier
    ds_read_b128 v[112:115], v148 offset:49152
    ds_read_b64_tr_b16 v[120:121], v152 offset:16384
    v_mfma_f32_32x32x16_bf16 v[48:63], v[132:135], v[136:139], v[48:63]
    ds_read_b64_tr_b16 v[122:123], v152 offset:17408
    ds_read_b128 v[116:119], v148 offset:53248
    v_mfma_f32_32x32x16_bf16 v[64:79], v[128:131], v[140:143], v[64:79]
    ds_read_b64_tr_b16 v[124:125], v153 offset:16384
    ds_read_b64_tr_b16 v[126:127], v153 offset:17408
    v_mfma_f32_32x32x16_bf16 v[80:95], v[132:135], v[140:143], v[80:95]
    v_mfma_f32_32x32x16_bf16 v[32:47], v[96:99], v[104:107], v[32:47]
    ds_read_b128 v[128:131], v149 offset:49152
    ds_read_b64_tr_b16 v[136:137], v152 offset:20480
    v_mfma_f32_32x32x16_bf16 v[48:63], v[100:103], v[104:107], v[48:63]
    ds_read_b64_tr_b16 v[138:139], v152 offset:21504
    ds_read_b128 v[132:135], v149 offset:53248
    v_mfma_f32_32x32x16_bf16 v[64:79], v[96:99], v[108:111], v[64:79]
    ds_read_b64_tr_b16 v[140:141], v153 offset:20480
    ds_read_b64_tr_b16 v[142:143], v153 offset:21504
    v_mfma_f32_32x32x16_bf16 v[80:95], v[100:103], v[108:111], v[80:95]
    s_waitcnt lgkmcnt(9)
    v_mfma_f32_32x32x16_bf16 v[32:47], v[112:115], v[120:123], v[32:47]
    s_waitcnt lgkmcnt(0)
    s_barrier
    ds_read_b128 v[96:99], v150 offset:49152
    ds_read_b64_tr_b16 v[104:105], v152 offset:24576
    v_mfma_f32_32x32x16_bf16 v[48:63], v[116:119], v[120:123], v[48:63]
    ds_read_b64_tr_b16 v[106:107], v152 offset:25600
    ds_read_b128 v[100:103], v150 offset:53248
    v_mfma_f32_32x32x16_bf16 v[64:79], v[112:115], v[124:127], v[64:79]
    ds_read_b64_tr_b16 v[108:109], v153 offset:24576
    ds_read_b64_tr_b16 v[110:111], v153 offset:25600
    v_mfma_f32_32x32x16_bf16 v[80:95], v[116:119], v[124:127], v[80:95]
    v_mfma_f32_32x32x16_bf16 v[32:47], v[128:131], v[136:139], v[32:47]
    ds_read_b128 v[112:115], v151 offset:49152
    ds_read_b64_tr_b16 v[120:121], v152 offset:28672
    v_mfma_f32_32x32x16_bf16 v[48:63], v[132:135], v[136:139], v[48:63]
    ds_read_b64_tr_b16 v[122:123], v152 offset:29696
    ds_read_b128 v[116:119], v151 offset:53248
    v_mfma_f32_32x32x16_bf16 v[64:79], v[128:131], v[140:143], v[64:79]
    ds_read_b64_tr_b16 v[124:125], v153 offset:28672
    ds_read_b64_tr_b16 v[126:127], v153 offset:29696
    v_mfma_f32_32x32x16_bf16 v[80:95], v[132:135], v[140:143], v[80:95]
    s_waitcnt lgkmcnt(9)
    v_mfma_f32_32x32x16_bf16 v[32:47], v[96:99], v[104:107], v[32:47]
    s_waitcnt lgkmcnt(0)
    s_barrier
    ds_read_b128 v[128:131], v144 offset:0
    ds_read_b64_tr_b16 v[136:137], v154 offset:0
    v_mfma_f32_32x32x16_bf16 v[48:63], v[100:103], v[104:107], v[48:63]
    ds_read_b64_tr_b16 v[138:139], v154 offset:512
    ds_read_b128 v[132:135], v144 offset:4096
    v_mfma_f32_32x32x16_bf16 v[64:79], v[96:99], v[108:111], v[64:79]
    v_mfma_f32_32x32x16_bf16 v[80:95], v[100:103], v[108:111], v[80:95]
    v_mfma_f32_32x32x16_bf16 v[32:47], v[112:115], v[120:123], v[32:47]
    ds_read_b128 v[96:99], v145 offset:0
    ds_read_b64_tr_b16 v[104:105], v154 offset:2048
    v_mfma_f32_32x32x16_bf16 v[48:63], v[116:119], v[120:123], v[48:63]
    ds_read_b64_tr_b16 v[106:107], v154 offset:2560
    ds_read_b128 v[100:103], v145 offset:4096
    v_mfma_f32_32x32x16_bf16 v[64:79], v[112:115], v[124:127], v[64:79]
    v_mfma_f32_32x32x16_bf16 v[80:95], v[116:119], v[124:127], v[80:95]
    s_waitcnt lgkmcnt(5)
    v_mfma_f32_32x32x16_bf16 v[0:15], v[136:139], v[128:131], 0
    ds_read_b128 v[112:115], v146 offset:0
    ds_read_b64_tr_b16 v[120:121], v154 offset:4096
    s_waitcnt lgkmcnt(6)
    v_mfma_f32_32x32x16_bf16 v[16:31], v[136:139], v[132:135], 0
    ds_read_b64_tr_b16 v[122:123], v154 offset:4608
    ds_read_b128 v[116:119], v146 offset:4096
    s_waitcnt lgkmcnt(5)
    v_mfma_f32_32x32x16_bf16 v[0:15], v[104:107], v[96:99], v[0:15]
    ds_read_b128 v[128:131], v147 offset:0
    ds_read_b64_tr_b16 v[136:137], v154 offset:6144
    v_mov_b32 v172, 0x3f803f80
    v_mov_b32 v173, 0x3f803f80
    v_mov_b32 v174, 0x3f803f80
    v_mov_b32 v175, 0x3f803f80
    s_nop 3
    v_cvt_pk_bf16_f32 v64, v64, v65
    v_cvt_pk_bf16_f32 v65, v66, v67
    v_cvt_pk_bf16_f32 v66, v68, v69
    v_cvt_pk_bf16_f32 v67, v70, v71
    v_cvt_pk_bf16_f32 v68, v72, v73
    s_waitcnt lgkmcnt(6)
    v_mfma_f32_32x32x16_bf16 v[16:31], v[104:107], v[100:103], v[16:31]
    ds_read_b64_tr_b16 v[138:139], v154 offset:6656
    ds_read_b128 v[132:135], v147 offset:4096
    v_cvt_pk_bf16_f32 v69, v74, v75
    v_cvt_pk_bf16_f32 v70, v76, v77
    v_cvt_pk_bf16_f32 v71, v78, v79
    v_cvt_pk_bf16_f32 v72, v80, v81
    v_cvt_pk_bf16_f32 v73, v82, v83
    v_cvt_pk_bf16_f32 v74, v84, v85
    v_cvt_pk_bf16_f32 v75, v86, v87
    v_cvt_pk_bf16_f32 v76, v88, v89
    v_cvt_pk_bf16_f32 v77, v90, v91
    v_cvt_pk_bf16_f32 v78, v92, v93
    s_waitcnt lgkmcnt(5)
    v_mfma_f32_32x32x16_bf16 v[0:15], v[120:123], v[112:115], v[0:15]
    s_waitcnt lgkmcnt(0)
    s_barrier
    ds_read_b128 v[96:99], v144 offset:16384
    ds_read_b64_tr_b16 v[104:105], v154 offset:8192
    v_cvt_pk_bf16_f32 v79, v94, v95
    v_mul_f32 v240, s70, v32
    v_mul_f32 v241, s70, v33
    v_mul_f32 v242, s70, v34
    v_mul_f32 v243, s70, v35
    v_mul_f32 v244, s70, v36
    v_mul_f32 v245, s70, v37
    v_mul_f32 v246, s70, v38
    v_mul_f32 v247, s70, v39
    v_exp_f32 v240, v240 clamp
    v_mfma_f32_32x32x16_bf16 v[16:31], v[120:123], v[116:119], v[16:31]
    ds_read_b64_tr_b16 v[106:107], v154 offset:8704
    ds_read_b128 v[100:103], v144 offset:20480
    v_exp_f32 v241, v241 clamp
    v_exp_f32 v242, v242 clamp
    v_exp_f32 v243, v243 clamp
    v_exp_f32 v244, v244 clamp
    v_exp_f32 v245, v245 clamp
    v_exp_f32 v246, v246 clamp
    v_exp_f32 v247, v247 clamp
    v_max_f32 v32, s72, v32
    v_max_f32 v33, s72, v33
    v_max_f32 v34, s72, v34
    v_mfma_f32_32x32x16_bf16 v[0:15], v[136:139], v[128:131], v[0:15]
    ds_read_b128 v[112:115], v145 offset:16384
    ds_read_b64_tr_b16 v[120:121], v154 offset:10240
    v_max_f32 v35, s72, v35
    v_max_f32 v36, s72, v36
    v_max_f32 v37, s72, v37
    v_max_f32 v38, s72, v38
    v_max_f32 v39, s72, v39
    v_add_f32 v240, v240, v32
    v_add_f32 v241, v241, v33
    v_add_f32 v242, v242, v34
    v_add_f32 v243, v243, v35
    v_add_f32 v244, v244, v36
    v_mfma_f32_32x32x16_bf16 v[16:31], v[136:139], v[132:135], v[16:31]
    ds_read_b64_tr_b16 v[122:123], v154 offset:10752
    ds_read_b128 v[116:119], v145 offset:20480
    v_add_f32 v245, v245, v37
    v_add_f32 v246, v246, v38
    v_add_f32 v247, v247, v39
    v_cvt_pk_bf16_f32 v32, v240, v241
    v_cvt_pk_bf16_f32 v33, v242, v243
    v_cvt_pk_bf16_f32 v34, v244, v245
    v_cvt_pk_bf16_f32 v35, v246, v247
    v_mul_f32 v240, s70, v40
    v_mul_f32 v241, s70, v41
    v_mul_f32 v242, s70, v42
    s_waitcnt lgkmcnt(5)
    v_mfma_f32_32x32x16_bf16 v[0:15], v[104:107], v[96:99], v[0:15]
    ds_read_b128 v[128:131], v146 offset:16384
    ds_read_b64_tr_b16 v[136:137], v154 offset:12288
    v_mfma_f32_32x32x16_bf16 v[156:171], v[32:35], v[64:67], 0
    v_mul_f32 v243, s70, v43
    v_mul_f32 v244, s70, v44
    v_mul_f32 v245, s70, v45
    v_mul_f32 v246, s70, v46
    v_mul_f32 v247, s70, v47
    v_exp_f32 v240, v240 clamp
    v_exp_f32 v241, v241 clamp
    v_exp_f32 v242, v242 clamp
    v_exp_f32 v243, v243 clamp
    s_waitcnt lgkmcnt(6)
    v_mfma_f32_32x32x16_bf16 v[16:31], v[104:107], v[100:103], v[16:31]
    ds_read_b64_tr_b16 v[138:139], v154 offset:12800
    ds_read_b128 v[132:135], v146 offset:20480
    v_exp_f32 v244, v244 clamp
    v_mfma_f32_32x32x16_bf16 v[80:95], v[32:35], v[172:175], 0
    v_exp_f32 v245, v245 clamp
    v_exp_f32 v246, v246 clamp
    v_exp_f32 v247, v247 clamp
    v_max_f32 v40, s72, v40
    v_max_f32 v41, s72, v41
    v_max_f32 v42, s72, v42
    v_max_f32 v43, s72, v43
    v_max_f32 v44, s72, v44
    s_waitcnt lgkmcnt(5)
    v_mfma_f32_32x32x16_bf16 v[0:15], v[120:123], v[112:115], v[0:15]
    ds_read_b128 v[96:99], v147 offset:16384
    ds_read_b64_tr_b16 v[104:105], v154 offset:14336
    v_max_f32 v45, s72, v45
    v_max_f32 v46, s72, v46
    v_max_f32 v47, s72, v47
    v_add_f32 v240, v240, v40
    v_add_f32 v241, v241, v41
    v_add_f32 v242, v242, v42
    v_add_f32 v243, v243, v43
    v_add_f32 v244, v244, v44
    v_add_f32 v245, v245, v45
    v_add_f32 v246, v246, v46
    s_waitcnt lgkmcnt(6)
    v_mfma_f32_32x32x16_bf16 v[16:31], v[120:123], v[116:119], v[16:31]
    ds_read_b64_tr_b16 v[106:107], v154 offset:14848
    ds_read_b128 v[100:103], v147 offset:20480
    v_add_f32 v247, v247, v47
    v_cvt_pk_bf16_f32 v36, v240, v241
    v_cvt_pk_bf16_f32 v37, v242, v243
    v_cvt_pk_bf16_f32 v38, v244, v245
    v_cvt_pk_bf16_f32 v39, v246, v247
    v_mul_f32 v240, s70, v48
    v_mul_f32 v241, s70, v49
    v_mul_f32 v242, s70, v50
    v_mfma_f32_32x32x16_bf16 v[156:171], v[36:39], v[68:71], v[156:171]
    v_mul_f32 v243, s70, v51
    s_waitcnt lgkmcnt(5)
    v_mfma_f32_32x32x16_bf16 v[0:15], v[136:139], v[128:131], v[0:15]
    s_waitcnt lgkmcnt(0)
    s_barrier
    ds_read_b128 v[112:115], v144 offset:32768
    ds_read_b64_tr_b16 v[120:121], v154 offset:16384
    v_mul_f32 v244, s70, v52
    v_mul_f32 v245, s70, v53
    v_mul_f32 v246, s70, v54
    v_mul_f32 v247, s70, v55
    v_exp_f32 v240, v240 clamp
    v_exp_f32 v241, v241 clamp
    v_exp_f32 v242, v242 clamp
    v_exp_f32 v243, v243 clamp
    v_exp_f32 v244, v244 clamp
    v_mfma_f32_32x32x16_bf16 v[80:95], v[36:39], v[172:175], v[80:95]
    v_mfma_f32_32x32x16_bf16 v[16:31], v[136:139], v[132:135], v[16:31]
    ds_read_b64_tr_b16 v[122:123], v154 offset:16896
    ds_read_b128 v[116:119], v144 offset:36864
    v_exp_f32 v245, v245 clamp
    v_exp_f32 v246, v246 clamp
    v_exp_f32 v247, v247 clamp
    v_max_f32 v48, s72, v48
    v_max_f32 v49, s72, v49
    v_max_f32 v50, s72, v50
    v_max_f32 v51, s72, v51
    v_max_f32 v52, s72, v52
    v_max_f32 v53, s72, v53
    v_max_f32 v54, s72, v54
    v_mfma_f32_32x32x16_bf16 v[0:15], v[104:107], v[96:99], v[0:15]
    ds_read_b128 v[128:131], v145 offset:32768
    ds_read_b64_tr_b16 v[136:137], v154 offset:18432
    v_max_f32 v55, s72, v55
    v_add_f32 v240, v240, v48
    v_add_f32 v241, v241, v49
    v_add_f32 v242, v242, v50
    v_add_f32 v243, v243, v51
    v_add_f32 v244, v244, v52
    v_add_f32 v245, v245, v53
    v_add_f32 v246, v246, v54
    v_add_f32 v247, v247, v55
    v_cvt_pk_bf16_f32 v40, v240, v241
    v_mfma_f32_32x32x16_bf16 v[16:31], v[104:107], v[100:103], v[16:31]
    ds_read_b64_tr_b16 v[138:139], v154 offset:18944
    ds_read_b128 v[132:135], v145 offset:36864
    v_cvt_pk_bf16_f32 v41, v242, v243
    v_cvt_pk_bf16_f32 v42, v244, v245
    v_cvt_pk_bf16_f32 v43, v246, v247
    v_mul_f32 v240, s70, v56
    v_mul_f32 v241, s70, v57
    v_mul_f32 v242, s70, v58
    v_mfma_f32_32x32x16_bf16 v[156:171], v[40:43], v[72:75], v[156:171]
    v_mul_f32 v243, s70, v59
    v_mul_f32 v244, s70, v60
    v_mul_f32 v245, s70, v61
    s_waitcnt lgkmcnt(5)
    v_mfma_f32_32x32x16_bf16 v[0:15], v[120:123], v[112:115], v[0:15]
    ds_read_b128 v[96:99], v146 offset:32768
    ds_read_b64_tr_b16 v[104:105], v154 offset:20480
    v_mul_f32 v246, s70, v62
    v_mul_f32 v247, s70, v63
    v_exp_f32 v240, v240 clamp
    v_exp_f32 v241, v241 clamp
    v_exp_f32 v242, v242 clamp
    v_exp_f32 v243, v243 clamp
    v_exp_f32 v244, v244 clamp
    v_mfma_f32_32x32x16_bf16 v[80:95], v[40:43], v[172:175], v[80:95]
    v_exp_f32 v245, v245 clamp
    v_exp_f32 v246, v246 clamp
    s_waitcnt lgkmcnt(6)
    v_mfma_f32_32x32x16_bf16 v[16:31], v[120:123], v[116:119], v[16:31]
    ds_read_b64_tr_b16 v[106:107], v154 offset:20992
    ds_read_b128 v[100:103], v146 offset:36864
    v_exp_f32 v247, v247 clamp
    v_max_f32 v56, s72, v56
    v_max_f32 v57, s72, v57
    v_max_f32 v58, s72, v58
    v_max_f32 v59, s72, v59
    v_max_f32 v60, s72, v60
    v_max_f32 v61, s72, v61
    v_max_f32 v62, s72, v62
    v_max_f32 v63, s72, v63
    v_add_f32 v240, v240, v56
    s_waitcnt lgkmcnt(5)
    v_mfma_f32_32x32x16_bf16 v[0:15], v[136:139], v[128:131], v[0:15]
    ds_read_b128 v[112:115], v147 offset:32768
    ds_read_b64_tr_b16 v[120:121], v154 offset:22528
    v_add_f32 v241, v241, v57
    v_add_f32 v242, v242, v58
    v_add_f32 v243, v243, v59
    v_add_f32 v244, v244, v60
    v_add_f32 v245, v245, v61
    v_add_f32 v246, v246, v62
    v_add_f32 v247, v247, v63
    v_cvt_pk_bf16_f32 v44, v240, v241
    v_cvt_pk_bf16_f32 v45, v242, v243
    v_cvt_pk_bf16_f32 v46, v244, v245
    s_waitcnt lgkmcnt(6)
    v_mfma_f32_32x32x16_bf16 v[16:31], v[136:139], v[132:135], v[16:31]
    ds_read_b64_tr_b16 v[122:123], v154 offset:23040
    ds_read_b128 v[116:119], v147 offset:36864
    v_cvt_pk_bf16_f32 v47, v246, v247
    s_nop 1
    v_mfma_f32_32x32x16_bf16 v[156:171], v[44:47], v[76:79], v[156:171]
    v_mfma_f32_32x32x16_bf16 v[80:95], v[44:47], v[172:175], v[80:95]
    s_nop 3
    s_waitcnt lgkmcnt(5)
    v_mfma_f32_32x32x16_bf16 v[0:15], v[104:107], v[96:99], v[0:15]
    s_waitcnt lgkmcnt(0)
    s_barrier
    ds_read_b128 v[128:131], v144 offset:49152
    ds_read_b64_tr_b16 v[136:137], v154 offset:24576
    v_mfma_f32_32x32x16_bf16 v[16:31], v[104:107], v[100:103], v[16:31]
    ds_read_b64_tr_b16 v[138:139], v154 offset:25088
    ds_read_b128 v[132:135], v144 offset:53248
    v_cndmask_b32 v156, v80, v156, s[74:75]
    v_cndmask_b32 v164, v164, v88, s[74:75]
    v_cndmask_b32 v157, v81, v157, s[74:75]
    v_cndmask_b32 v165, v165, v89, s[74:75]
    v_cndmask_b32 v158, v82, v158, s[74:75]
    v_mfma_f32_32x32x16_bf16 v[0:15], v[120:123], v[112:115], v[0:15]
    ds_read_b128 v[96:99], v145 offset:49152
    ds_read_b64_tr_b16 v[104:105], v154 offset:26624
    v_cndmask_b32 v166, v166, v90, s[74:75]
    v_cndmask_b32 v159, v83, v159, s[74:75]
    v_cndmask_b32 v167, v167, v91, s[74:75]
    v_cndmask_b32 v160, v84, v160, s[74:75]
    v_cndmask_b32 v168, v168, v92, s[74:75]
    v_cndmask_b32 v161, v85, v161, s[74:75]
    v_cndmask_b32 v169, v169, v93, s[74:75]
    v_cndmask_b32 v162, v86, v162, s[74:75]
    v_cndmask_b32 v170, v170, v94, s[74:75]
    v_cndmask_b32 v163, v87, v163, s[74:75]
    v_mfma_f32_32x32x16_bf16 v[16:31], v[120:123], v[116:119], v[16:31]
    ds_read_b64_tr_b16 v[106:107], v154 offset:27136
    ds_read_b128 v[100:103], v145 offset:53248
    v_cndmask_b32 v171, v171, v95, s[74:75]
    v_cndmask_b32 v48, v164, v156, s[66:67]
    v_cndmask_b32 v49, v165, v157, s[66:67]
    v_cndmask_b32 v50, v166, v158, s[66:67]
    v_cndmask_b32 v51, v167, v159, s[66:67]
    v_cndmask_b32 v52, v168, v160, s[66:67]
    v_cndmask_b32 v53, v169, v161, s[66:67]
    v_cndmask_b32 v54, v170, v162, s[66:67]
    v_cndmask_b32 v55, v171, v163, s[66:67]
    ds_write_b128 v235, v[48:51]
    s_waitcnt lgkmcnt(6)
    v_mfma_f32_32x32x16_bf16 v[0:15], v[136:139], v[128:131], v[0:15]
    ds_read_b128 v[112:115], v146 offset:49152
    ds_read_b64_tr_b16 v[120:121], v154 offset:28672
    ds_write_b128 v235, v[52:55] offset:1024
    v_cndmask_b32 v156, v156, v164, s[66:67]
    v_cndmask_b32 v157, v157, v165, s[66:67]
    v_cndmask_b32 v158, v158, v166, s[66:67]
    v_cndmask_b32 v159, v159, v167, s[66:67]
    v_cndmask_b32 v160, v160, v168, s[66:67]
    v_cndmask_b32 v161, v161, v169, s[66:67]
    v_cndmask_b32 v162, v162, v170, s[66:67]
    v_cndmask_b32 v163, v163, v171, s[66:67]
    s_waitcnt lgkmcnt(8)
    v_mfma_f32_32x32x16_bf16 v[16:31], v[136:139], v[132:135], v[16:31]
    ds_read_b64_tr_b16 v[122:123], v154 offset:29184
    ds_read_b128 v[116:119], v146 offset:53248
    s_waitcnt lgkmcnt(7)
    v_mfma_f32_32x32x16_bf16 v[0:15], v[104:107], v[96:99], v[0:15]
    ds_read_b128 v[128:131], v147 offset:49152
    ds_read_b64_tr_b16 v[136:137], v154 offset:30720
    s_waitcnt lgkmcnt(8)
    v_mfma_f32_32x32x16_bf16 v[16:31], v[104:107], v[100:103], v[16:31]
    ds_read_b64_tr_b16 v[138:139], v154 offset:31232
    ds_read_b128 v[132:135], v147 offset:53248
    s_waitcnt lgkmcnt(5)
    v_mfma_f32_32x32x16_bf16 v[0:15], v[120:123], v[112:115], v[0:15]
    s_waitcnt lgkmcnt(0)
    s_barrier
    ds_read_b128 v[96:99], v148 offset:0
    ds_read_b64_tr_b16 v[104:105], v154 offset:0
    ds_read_b128 v[80:83], v234
    ds_read_b128 v[84:87], v234 offset:1024
    v_mfma_f32_32x32x16_bf16 v[16:31], v[120:123], v[116:119], v[16:31]
    ds_read_b64_tr_b16 v[106:107], v154 offset:512
    ds_read_b128 v[100:103], v148 offset:4096
    s_waitcnt lgkmcnt(2)
    v_add_f32 v156, v156, v80
    v_add_f32 v157, v157, v81
    v_add_f32 v158, v158, v82
    v_add_f32 v159, v159, v83
    v_add_f32 v160, v160, v84
    v_add_f32 v161, v161, v85
    v_add_f32 v162, v162, v86
    v_add_f32 v163, v163, v87
    v_cvt_pk_bf16_f32 v164, v156, v157
    v_cvt_pk_bf16_f32 v165, v158, v159
    v_mfma_f32_32x32x16_bf16 v[0:15], v[136:139], v[128:131], v[0:15]
    ds_read_b128 v[112:115], v149 offset:0
    ds_read_b64_tr_b16 v[120:121], v154 offset:2048
    v_cvt_pk_bf16_f32 v166, v160, v161
    v_cvt_pk_bf16_f32 v167, v162, v163
    s_mov_b64 exec, s[78:79]
    buffer_store_dwordx4 v[164:167], v233, s[20:23], s76 offen sc1
    s_mov_b64 exec, -1
    v_mfma_f32_32x32x16_bf16 v[16:31], v[136:139], v[132:135], v[16:31]
    ds_read_b64_tr_b16 v[122:123], v154 offset:2560
    ds_read_b128 v[116:119], v149 offset:4096
    s_waitcnt lgkmcnt(5)
    v_mfma_f32_32x32x16_bf16 v[0:15], v[104:107], v[96:99], v[0:15]
    ds_read_b128 v[128:131], v150 offset:0
    ds_read_b64_tr_b16 v[136:137], v154 offset:4096
    s_waitcnt lgkmcnt(6)
    v_mfma_f32_32x32x16_bf16 v[16:31], v[104:107], v[100:103], v[16:31]
    ds_read_b64_tr_b16 v[138:139], v154 offset:4608
    ds_read_b128 v[132:135], v150 offset:4096
    s_waitcnt lgkmcnt(5)
    v_mfma_f32_32x32x16_bf16 v[0:15], v[120:123], v[112:115], v[0:15]
    ds_read_b128 v[96:99], v151 offset:0
    ds_read_b64_tr_b16 v[104:105], v154 offset:6144
    s_waitcnt lgkmcnt(6)
    v_mfma_f32_32x32x16_bf16 v[16:31], v[120:123], v[116:119], v[16:31]
    ds_read_b64_tr_b16 v[106:107], v154 offset:6656
    ds_read_b128 v[100:103], v151 offset:4096
    s_waitcnt lgkmcnt(5)
    v_mfma_f32_32x32x16_bf16 v[0:15], v[136:139], v[128:131], v[0:15]
    ds_read_b128 v[112:115], v148 offset:16384
    ds_read_b64_tr_b16 v[120:121], v154 offset:8192
    s_waitcnt lgkmcnt(6)
    v_mfma_f32_32x32x16_bf16 v[16:31], v[136:139], v[132:135], v[16:31]
    ds_read_b64_tr_b16 v[122:123], v154 offset:8704
    ds_read_b128 v[116:119], v148 offset:20480
    s_waitcnt lgkmcnt(5)
    v_mfma_f32_32x32x16_bf16 v[0:15], v[104:107], v[96:99], v[0:15]
    ds_read_b128 v[128:131], v149 offset:16384
    ds_read_b64_tr_b16 v[136:137], v154 offset:10240
    s_waitcnt lgkmcnt(6)
    v_mfma_f32_32x32x16_bf16 v[16:31], v[104:107], v[100:103], v[16:31]
    ds_read_b64_tr_b16 v[138:139], v154 offset:10752
    ds_read_b128 v[132:135], v149 offset:20480
    s_waitcnt lgkmcnt(5)
    v_mfma_f32_32x32x16_bf16 v[0:15], v[120:123], v[112:115], v[0:15]
    ds_read_b128 v[96:99], v150 offset:16384
    ds_read_b64_tr_b16 v[104:105], v154 offset:12288
    s_waitcnt lgkmcnt(6)
    v_mfma_f32_32x32x16_bf16 v[16:31], v[120:123], v[116:119], v[16:31]
    ds_read_b64_tr_b16 v[106:107], v154 offset:12800
    ds_read_b128 v[100:103], v150 offset:20480
    s_waitcnt lgkmcnt(5)
    v_mfma_f32_32x32x16_bf16 v[0:15], v[136:139], v[128:131], v[0:15]
    ds_read_b128 v[112:115], v151 offset:16384
    ds_read_b64_tr_b16 v[120:121], v154 offset:14336
    s_waitcnt lgkmcnt(6)
    v_mfma_f32_32x32x16_bf16 v[16:31], v[136:139], v[132:135], v[16:31]
    ds_read_b64_tr_b16 v[122:123], v154 offset:14848
    ds_read_b128 v[116:119], v151 offset:20480
    s_waitcnt lgkmcnt(5)
    v_mfma_f32_32x32x16_bf16 v[0:15], v[104:107], v[96:99], v[0:15]
    s_waitcnt lgkmcnt(0)
    s_barrier
    ds_read_b128 v[128:131], v148 offset:32768
    ds_read_b64_tr_b16 v[136:137], v155 offset:16384
    v_mfma_f32_32x32x16_bf16 v[16:31], v[104:107], v[100:103], v[16:31]
    ds_read_b64_tr_b16 v[138:139], v155 offset:16896
    ds_read_b128 v[132:135], v148 offset:36864
    v_mfma_f32_32x32x16_bf16 v[0:15], v[120:123], v[112:115], v[0:15]
    ds_read_b128 v[96:99], v149 offset:32768
    ds_read_b64_tr_b16 v[104:105], v155 offset:18432
    v_mfma_f32_32x32x16_bf16 v[16:31], v[120:123], v[116:119], v[16:31]
    ds_read_b64_tr_b16 v[106:107], v155 offset:18944
    ds_read_b128 v[100:103], v149 offset:36864
    s_waitcnt lgkmcnt(5)
    v_mfma_f32_32x32x16_bf16 v[0:15], v[136:139], v[128:131], v[0:15]
    ds_read_b128 v[112:115], v150 offset:32768
    ds_read_b64_tr_b16 v[120:121], v155 offset:20480
    s_waitcnt lgkmcnt(6)
    v_mfma_f32_32x32x16_bf16 v[16:31], v[136:139], v[132:135], v[16:31]
    ds_read_b64_tr_b16 v[122:123], v155 offset:20992
    ds_read_b128 v[116:119], v150 offset:36864
    s_waitcnt lgkmcnt(5)
    v_mfma_f32_32x32x16_bf16 v[0:15], v[104:107], v[96:99], v[0:15]
    ds_read_b128 v[128:131], v151 offset:32768
    ds_read_b64_tr_b16 v[136:137], v155 offset:22528
    s_waitcnt lgkmcnt(6)
    v_mfma_f32_32x32x16_bf16 v[16:31], v[104:107], v[100:103], v[16:31]
    ds_read_b64_tr_b16 v[138:139], v155 offset:23040
    ds_read_b128 v[132:135], v151 offset:36864
    s_waitcnt lgkmcnt(5)
    v_mfma_f32_32x32x16_bf16 v[0:15], v[120:123], v[112:115], v[0:15]
    ds_read_b128 v[96:99], v148 offset:49152
    ds_read_b64_tr_b16 v[104:105], v155 offset:24576
    s_waitcnt lgkmcnt(6)
    v_mfma_f32_32x32x16_bf16 v[16:31], v[120:123], v[116:119], v[16:31]
    ds_read_b64_tr_b16 v[106:107], v155 offset:25088
    ds_read_b128 v[100:103], v148 offset:53248
    s_waitcnt lgkmcnt(5)
    v_mfma_f32_32x32x16_bf16 v[0:15], v[136:139], v[128:131], v[0:15]
    ds_read_b128 v[112:115], v149 offset:49152
    ds_read_b64_tr_b16 v[120:121], v155 offset:26624
    s_waitcnt vmcnt(0)
    v_mov_b32 v253, 0
    v_mov_b32 v255, s62
    s_mov_b64 exec, 1
    buffer_store_dword v255, v253, s[20:23], s77 offen sc1
    s_mov_b64 exec, -1
    s_waitcnt lgkmcnt(6)
    v_mfma_f32_32x32x16_bf16 v[16:31], v[136:139], v[132:135], v[16:31]
    ds_read_b64_tr_b16 v[122:123], v155 offset:27136
    ds_read_b128 v[116:119], v149 offset:53248
    s_waitcnt lgkmcnt(5)
    v_mfma_f32_32x32x16_bf16 v[0:15], v[104:107], v[96:99], v[0:15]
    ds_read_b128 v[128:131], v150 offset:49152
    ds_read_b64_tr_b16 v[136:137], v155 offset:28672
    s_waitcnt lgkmcnt(6)
    v_mfma_f32_32x32x16_bf16 v[16:31], v[104:107], v[100:103], v[16:31]
    ds_read_b64_tr_b16 v[138:139], v155 offset:29184
    ds_read_b128 v[132:135], v150 offset:53248
    s_waitcnt lgkmcnt(5)
    v_mfma_f32_32x32x16_bf16 v[0:15], v[120:123], v[112:115], v[0:15]
    ds_read_b128 v[96:99], v151 offset:49152
    ds_read_b64_tr_b16 v[104:105], v155 offset:30720
    s_waitcnt lgkmcnt(6)
    v_mfma_f32_32x32x16_bf16 v[16:31], v[120:123], v[116:119], v[16:31]
    ds_read_b64_tr_b16 v[106:107], v155 offset:31232
    ds_read_b128 v[100:103], v151 offset:53248
    s_waitcnt lgkmcnt(5)
    v_mfma_f32_32x32x16_bf16 v[0:15], v[136:139], v[128:131], v[0:15]
    s_waitcnt lgkmcnt(0)
    s_barrier
    v_mfma_f32_32x32x16_bf16 v[16:31], v[136:139], v[132:135], v[16:31]
    v_mfma_f32_32x32x16_bf16 v[0:15], v[104:107], v[96:99], v[0:15]
    v_mfma_f32_32x32x16_bf16 v[16:31], v[104:107], v[100:103], v[16:31]
    s_waitcnt lgkmcnt(0)
    s_nop 11
    s_barrier
    v_pk_mul_f32 v[240:241], v[0:1], s[70:71] op_sel_hi:[1,0]
    v_pk_mul_f32 v[242:243], v[2:3], s[70:71] op_sel_hi:[1,0]
    ds_read_b64_tr_b16 v[120:121], v216 offset:32768
    v_pk_mul_f32 v[244:245], v[4:5], s[70:71] op_sel_hi:[1,0]
    v_pk_mul_f32 v[246:247], v[6:7], s[70:71] op_sel_hi:[1,0]
    ds_read_b64_tr_b16 v[122:123], v216 offset:33792
    v_exp_f32 v240, v240 clamp
    v_exp_f32 v241, v241 clamp
    ds_read_b64_tr_b16 v[124:125], v217 offset:32768
    v_exp_f32 v242, v242 clamp
    v_exp_f32 v243, v243 clamp
    ds_read_b64_tr_b16 v[126:127], v217 offset:33792
    v_exp_f32 v244, v244 clamp
    v_exp_f32 v245, v245 clamp
    ds_read_b64_tr_b16 v[128:129], v216 offset:40960
    v_exp_f32 v246, v246 clamp
    v_exp_f32 v247, v247 clamp
    ds_read_b64_tr_b16 v[130:131], v216 offset:41984
    v_max_f32 v0, s72, v0
    v_max_f32 v1, s72, v1
    ds_read_b64_tr_b16 v[132:133], v217 offset:40960
    v_max_f32 v2, s72, v2
    v_max_f32 v3, s72, v3
    ds_read_b64_tr_b16 v[134:135], v217 offset:41984
    s_waitcnt lgkmcnt(8)
    v_max_f32 v4, s72, v4
    v_max_f32 v5, s72, v5
    ds_read_b64_tr_b16 v[144:145], v216 offset:49152
    v_max_f32 v6, s72, v6
    v_max_f32 v7, s72, v7
    ds_read_b64_tr_b16 v[146:147], v216 offset:50176
    v_pk_add_f32 v[240:241], v[240:241], v[0:1]
    v_pk_add_f32 v[242:243], v[242:243], v[2:3]
    ds_read_b64_tr_b16 v[148:149], v217 offset:49152
    v_pk_add_f32 v[244:245], v[244:245], v[4:5]
    v_pk_add_f32 v[246:247], v[246:247], v[6:7]
    ds_read_b64_tr_b16 v[150:151], v217 offset:50176
    s_waitcnt lgkmcnt(8)
    v_cvt_pk_bf16_f32 v0, v240, v241
    v_cvt_pk_bf16_f32 v1, v242, v243
    ds_read_b64_tr_b16 v[152:153], v216 offset:57344
    v_cvt_pk_bf16_f32 v2, v244, v245
    v_cvt_pk_bf16_f32 v3, v246, v247
    ds_read_b64_tr_b16 v[154:155], v216 offset:58368
    v_pk_mul_f32 v[240:241], v[8:9], s[70:71] op_sel_hi:[1,0]
    v_pk_mul_f32 v[242:243], v[10:11], s[70:71] op_sel_hi:[1,0]
    ds_read_b64_tr_b16 v[156:157], v217 offset:57344
    v_pk_mul_f32 v[244:245], v[12:13], s[70:71] op_sel_hi:[1,0]
    v_pk_mul_f32 v[246:247], v[14:15], s[70:71] op_sel_hi:[1,0]
    ds_read_b64_tr_b16 v[158:159], v217 offset:58368
    s_waitcnt lgkmcnt(8)
    v_exp_f32 v240, v240 clamp
    v_exp_f32 v241, v241 clamp
    v_add_u32 v216, 65536, v216
    v_add_u32 v217, 65536, v217
    v_exp_f32 v242, v242 clamp
    v_exp_f32 v243, v243 clamp
    ds_read_b64_tr_b16 v[168:169], v216 offset:0
    v_exp_f32 v244, v244 clamp
    v_exp_f32 v245, v245 clamp
    ds_read_b64_tr_b16 v[170:171], v216 offset:1024
    v_exp_f32 v246, v246 clamp
    v_exp_f32 v247, v247 clamp
    ds_read_b64_tr_b16 v[172:173], v217 offset:0
    v_max_f32 v8, s72, v8
    v_max_f32 v9, s72, v9
    ds_read_b64_tr_b16 v[174:175], v217 offset:1024
    s_waitcnt lgkmcnt(8)
    v_max_f32 v10, s72, v10
    v_max_f32 v11, s72, v11
    ds_read_b64_tr_b16 v[176:177], v216 offset:8192
    v_max_f32 v12, s72, v12
    v_max_f32 v13, s72, v13
    ds_read_b64_tr_b16 v[178:179], v216 offset:9216
    v_max_f32 v14, s72, v14
    v_max_f32 v15, s72, v15
    ds_read_b64_tr_b16 v[180:181], v217 offset:8192
    v_pk_add_f32 v[240:241], v[240:241], v[8:9]
    v_pk_add_f32 v[242:243], v[242:243], v[10:11]
    ds_read_b64_tr_b16 v[182:183], v217 offset:9216
    s_waitcnt lgkmcnt(8)
    v_pk_add_f32 v[244:245], v[244:245], v[12:13]
    v_pk_add_f32 v[246:247], v[246:247], v[14:15]
    ds_read_b64_tr_b16 v[192:193], v216 offset:16384
    v_cvt_pk_bf16_f32 v4, v240, v241
    v_cvt_pk_bf16_f32 v5, v242, v243
    ds_read_b64_tr_b16 v[194:195], v216 offset:17408
    v_cvt_pk_bf16_f32 v6, v244, v245
    v_cvt_pk_bf16_f32 v7, v246, v247
    ds_read_b64_tr_b16 v[196:197], v217 offset:16384
    v_pk_mul_f32 v[240:241], v[16:17], s[70:71] op_sel_hi:[1,0]
    v_pk_mul_f32 v[242:243], v[18:19], s[70:71] op_sel_hi:[1,0]
    ds_read_b64_tr_b16 v[198:199], v217 offset:17408
    s_waitcnt lgkmcnt(8)
    v_pk_mul_f32 v[244:245], v[20:21], s[70:71] op_sel_hi:[1,0]
    v_pk_mul_f32 v[246:247], v[22:23], s[70:71] op_sel_hi:[1,0]
    ds_read_b64_tr_b16 v[200:201], v216 offset:24576
    v_exp_f32 v240, v240 clamp
    v_exp_f32 v241, v241 clamp
    ds_read_b64_tr_b16 v[202:203], v216 offset:25600
    v_exp_f32 v242, v242 clamp
    v_exp_f32 v243, v243 clamp
    ds_read_b64_tr_b16 v[204:205], v217 offset:24576
    v_exp_f32 v244, v244 clamp
    v_exp_f32 v245, v245 clamp
    ds_read_b64_tr_b16 v[206:207], v217 offset:25600
    s_waitcnt lgkmcnt(8)
    v_exp_f32 v246, v246 clamp
    v_exp_f32 v247, v247 clamp
    v_add_u32 v216, 65536, v216
    v_add_u32 v217, 65536, v217
    v_max_f32 v16, s72, v16
    v_max_f32 v17, s72, v17
    ds_read_b64_tr_b16 v[184:185], v216 offset:0
    v_max_f32 v18, s72, v18
    v_max_f32 v19, s72, v19
    ds_read_b64_tr_b16 v[186:187], v216 offset:1024
    v_max_f32 v20, s72, v20
    v_max_f32 v21, s72, v21
    ds_read_b64_tr_b16 v[188:189], v217 offset:0
    v_max_f32 v22, s72, v22
    v_max_f32 v23, s72, v23
    ds_read_b64_tr_b16 v[190:191], v217 offset:1024
    s_waitcnt lgkmcnt(8)
    v_pk_add_f32 v[240:241], v[240:241], v[16:17]
    v_pk_add_f32 v[242:243], v[242:243], v[18:19]
    ds_read_b64_tr_b16 v[208:209], v216 offset:8192
    v_pk_add_f32 v[244:245], v[244:245], v[20:21]
    v_pk_add_f32 v[246:247], v[246:247], v[22:23]
    ds_read_b64_tr_b16 v[210:211], v216 offset:9216
    v_cvt_pk_bf16_f32 v8, v240, v241
    v_cvt_pk_bf16_f32 v9, v242, v243
    ds_read_b64_tr_b16 v[212:213], v217 offset:8192
    v_cvt_pk_bf16_f32 v10, v244, v245
    v_cvt_pk_bf16_f32 v11, v246, v247
    ds_read_b64_tr_b16 v[214:215], v217 offset:9216
    s_waitcnt lgkmcnt(8)
    v_pk_mul_f32 v[240:241], v[24:25], s[70:71] op_sel_hi:[1,0]
    v_pk_mul_f32 v[242:243], v[26:27], s[70:71] op_sel_hi:[1,0]
    ds_read_b64_tr_b16 v[136:137], v216 offset:16384
    v_pk_mul_f32 v[244:245], v[28:29], s[70:71] op_sel_hi:[1,0]
    v_pk_mul_f32 v[246:247], v[30:31], s[70:71] op_sel_hi:[1,0]
    ds_read_b64_tr_b16 v[138:139], v216 offset:17408
    v_exp_f32 v240, v240 clamp
    v_exp_f32 v241, v241 clamp
    ds_read_b64_tr_b16 v[140:141], v217 offset:16384
    v_exp_f32 v242, v242 clamp
    v_exp_f32 v243, v243 clamp
    ds_read_b64_tr_b16 v[142:143], v217 offset:17408
    s_waitcnt lgkmcnt(8)
    v_exp_f32 v244, v244 clamp
    v_exp_f32 v245, v245 clamp
    ds_read_b64_tr_b16 v[160:161], v216 offset:24576
    v_exp_f32 v246, v246 clamp
    v_exp_f32 v247, v247 clamp
    ds_read_b64_tr_b16 v[162:163], v216 offset:25600
    v_max_f32 v24, s72, v24
    v_max_f32 v25, s72, v25
    ds_read_b64_tr_b16 v[164:165], v217 offset:24576
    v_max_f32 v26, s72, v26
    v_max_f32 v27, s72, v27
    ds_read_b64_tr_b16 v[166:167], v217 offset:25600
    s_waitcnt lgkmcnt(8)
    v_max_f32 v28, s72, v28
    v_max_f32 v29, s72, v29
    v_max_f32 v30, s72, v30
    v_max_f32 v31, s72, v31
    v_pk_add_f32 v[240:241], v[240:241], v[24:25]
    v_pk_add_f32 v[242:243], v[242:243], v[26:27]
    v_pk_add_f32 v[244:245], v[244:245], v[28:29]
    v_pk_add_f32 v[246:247], v[246:247], v[30:31]
    v_cvt_pk_bf16_f32 v12, v240, v241
    v_cvt_pk_bf16_f32 v13, v242, v243
    v_cvt_pk_bf16_f32 v14, v244, v245
    v_cvt_pk_bf16_f32 v15, v246, v247
    ds_write_b128 v234, v[0:3] offset:0
    ds_write_b128 v234, v[4:7] offset:1024
    ds_write_b128 v234, v[8:11] offset:2048
    ds_write_b128 v234, v[12:15] offset:3072
    s_waitcnt lgkmcnt(0)
    s_barrier
    buffer_load_dword v250, v218, s[20:23], s46 offen sc1
    s_add_u32 m0, s0, 32768
    s_add_u32 s35, s1, 917504
    buffer_load_dwordx4 v236, s[12:15], s35 offen lds
    s_add_u32 m0, s0, 36864
    s_nop 0
    buffer_load_dwordx4 v237, s[12:15], s35 offen lds
    s_add_u32 m0, s0, 40960
    s_add_u32 s35, s1, 1114112
    buffer_load_dwordx4 v236, s[12:15], s35 offen lds
    s_add_u32 m0, s0, 45056
    s_nop 0
    buffer_load_dwordx4 v237, s[12:15], s35 offen lds
    s_add_u32 m0, s0, 147456
    s_add_u32 s35, s1, 1310720
    buffer_load_dwordx4 v236, s[12:15], s35 offen lds
    s_add_u32 m0, s0, 151552
    s_nop 0
    buffer_load_dwordx4 v237, s[12:15], s35 offen lds
    s_add_u32 m0, s0, 49152
    s_add_u32 s35, s1, 1376256
    buffer_load_dwordx4 v236, s[12:15], s35 offen lds
    s_add_u32 m0, s0, 53248
    s_nop 0
    buffer_load_dwordx4 v237, s[12:15], s35 offen lds
    s_add_u32 m0, s0, 57344
    s_add_u32 s35, s1, 0
    buffer_load_dwordx4 v236, s[16:19], s35 offen lds
    s_add_u32 m0, s0, 61440
    s_nop 0
    buffer_load_dwordx4 v237, s[16:19], s35 offen lds
    s_add_u32 m0, s0, 155648
    s_add_u32 s35, s1, 65536
    buffer_load_dwordx4 v236, s[16:19], s35 offen lds
    s_add_u32 m0, s0, 159744
    s_nop 0
    buffer_load_dwordx4 v237, s[16:19], s35 offen lds
    s_waitcnt vmcnt(12)
    s_barrier
    s_add_u32 m0, s0, 65536
    s_add_u32 s35, s1, 131072
    buffer_load_dwordx4 v236, s[16:19], s35 offen lds
    s_add_u32 m0, s0, 69632
    s_nop 0
    buffer_load_dwordx4 v237, s[16:19], s35 offen lds
    s_add_u32 m0, s0, 73728
    s_add_u32 s35, s1, 262144
    buffer_load_dwordx4 v236, s[16:19], s35 offen lds
    s_add_u32 m0, s0, 77824
    s_nop 0
    buffer_load_dwordx4 v237, s[16:19], s35 offen lds
    s_add_u32 m0, s0, 131072
    s_add_u32 s35, s1, 327680
    buffer_load_dwordx4 v236, s[16:19], s35 offen lds
    s_add_u32 m0, s0, 135168
    s_nop 0
    buffer_load_dwordx4 v237, s[16:19], s35 offen lds
    s_add_u32 m0, s0, 81920
    s_add_u32 s35, s1, 393216
    buffer_load_dwordx4 v236, s[16:19], s35 offen lds
    s_add_u32 m0, s0, 86016
    s_nop 0
    buffer_load_dwordx4 v237, s[16:19], s35 offen lds
    s_add_u32 m0, s0, 90112
    s_add_u32 s35, s1, 458752
    buffer_load_dwordx4 v236, s[16:19], s35 offen lds
    s_add_u32 m0, s0, 94208
    s_nop 0
    buffer_load_dwordx4 v237, s[16:19], s35 offen lds
    s_add_u32 m0, s0, 139264
    s_add_u32 s35, s1, 196608
    buffer_load_dwordx4 v236, s[16:19], s35 offen lds
    s_add_u32 m0, s0, 143360
    s_nop 0
    buffer_load_dwordx4 v237, s[16:19], s35 offen lds
    s_branch L_phase2_a
L_c_ffn:
    ds_read_b128 v[96:99], v144 offset:0
    ds_read_b64_tr_b16 v[104:105], v152 offset:0
    ds_read_b64_tr_b16 v[106:107], v152 offset:1024
    ds_read_b128 v[100:103], v144 offset:4096
    ds_read_b64_tr_b16 v[108:109], v153 offset:0
    ds_read_b64_tr_b16 v[110:111], v153 offset:1024
    ds_read_b128 v[112:115], v145 offset:0
    ds_read_b64_tr_b16 v[120:121], v152 offset:4096
    ds_read_b64_tr_b16 v[122:123], v152 offset:5120
    ds_read_b128 v[116:119], v145 offset:4096
    ds_read_b64_tr_b16 v[124:125], v153 offset:4096
    ds_read_b64_tr_b16 v[126:127], v153 offset:5120
    s_waitcnt lgkmcnt(9)
    v_mfma_f32_32x32x16_bf16 v[0:15], v[104:107], v[96:99], 0
    s_waitcnt lgkmcnt(0)
    s_barrier
    ds_read_b128 v[128:131], v146 offset:0
    ds_read_b64_tr_b16 v[136:137], v152 offset:8192
    v_mfma_f32_32x32x16_bf16 v[16:31], v[104:107], v[100:103], 0
    ds_read_b64_tr_b16 v[138:139], v152 offset:9216
    ds_read_b128 v[132:135], v146 offset:4096
    v_mfma_f32_32x32x16_bf16 v[32:47], v[108:111], v[96:99], 0
    ds_read_b64_tr_b16 v[140:141], v153 offset:8192
    ds_read_b64_tr_b16 v[142:143], v153 offset:9216
    v_mfma_f32_32x32x16_bf16 v[48:63], v[108:111], v[100:103], 0
    v_mfma_f32_32x32x16_bf16 v[0:15], v[120:123], v[112:115], v[0:15]
    ds_read_b128 v[96:99], v147 offset:0
    ds_read_b64_tr_b16 v[104:105], v152 offset:12288
    v_mfma_f32_32x32x16_bf16 v[16:31], v[120:123], v[116:119], v[16:31]
    ds_read_b64_tr_b16 v[106:107], v152 offset:13312
    ds_read_b128 v[100:103], v147 offset:4096
    v_mfma_f32_32x32x16_bf16 v[32:47], v[124:127], v[112:115], v[32:47]
    ds_read_b64_tr_b16 v[108:109], v153 offset:12288
    ds_read_b64_tr_b16 v[110:111], v153 offset:13312
    v_mfma_f32_32x32x16_bf16 v[48:63], v[124:127], v[116:119], v[48:63]
    s_waitcnt lgkmcnt(9)
    v_mfma_f32_32x32x16_bf16 v[0:15], v[136:139], v[128:131], v[0:15]
    s_waitcnt lgkmcnt(0)
    s_barrier
    ds_read_b128 v[112:115], v144 offset:16384
    ds_read_b64_tr_b16 v[120:121], v152 offset:16384
    v_mfma_f32_32x32x16_bf16 v[16:31], v[136:139], v[132:135], v[16:31]
    ds_read_b64_tr_b16 v[122:123], v152 offset:17408
    ds_read_b128 v[116:119], v144 offset:20480
    v_mfma_f32_32x32x16_bf16 v[32:47], v[140:143], v[128:131], v[32:47]
    ds_read_b64_tr_b16 v[124:125], v153 offset:16384
    ds_read_b64_tr_b16 v[126:127], v153 offset:17408
    v_mfma_f32_32x32x16_bf16 v[48:63], v[140:143], v[132:135], v[48:63]
    v_mfma_f32_32x32x16_bf16 v[0:15], v[104:107], v[96:99], v[0:15]
    ds_read_b128 v[128:131], v145 offset:16384
    ds_read_b64_tr_b16 v[136:137], v152 offset:20480
    v_mfma_f32_32x32x16_bf16 v[16:31], v[104:107], v[100:103], v[16:31]
    ds_read_b64_tr_b16 v[138:139], v152 offset:21504
    ds_read_b128 v[132:135], v145 offset:20480
    v_mfma_f32_32x32x16_bf16 v[32:47], v[108:111], v[96:99], v[32:47]
    ds_read_b64_tr_b16 v[140:141], v153 offset:20480
    ds_read_b64_tr_b16 v[142:143], v153 offset:21504
    v_mfma_f32_32x32x16_bf16 v[48:63], v[108:111], v[100:103], v[48:63]
    s_waitcnt lgkmcnt(9)
    v_mfma_f32_32x32x16_bf16 v[0:15], v[120:123], v[112:115], v[0:15]
    s_waitcnt lgkmcnt(0)
    s_barrier
    ds_read_b128 v[96:99], v146 offset:16384
    ds_read_b64_tr_b16 v[104:105], v152 offset:24576
    v_mfma_f32_32x32x16_bf16 v[16:31], v[120:123], v[116:119], v[16:31]
    ds_read_b64_tr_b16 v[106:107], v152 offset:25600
    ds_read_b128 v[100:103], v146 offset:20480
    v_mfma_f32_32x32x16_bf16 v[32:47], v[124:127], v[112:115], v[32:47]
    ds_read_b64_tr_b16 v[108:109], v153 offset:24576
    ds_read_b64_tr_b16 v[110:111], v153 offset:25600
    v_mfma_f32_32x32x16_bf16 v[48:63], v[124:127], v[116:119], v[48:63]
    v_mfma_f32_32x32x16_bf16 v[0:15], v[136:139], v[128:131], v[0:15]
    ds_read_b128 v[112:115], v147 offset:16384
    ds_read_b64_tr_b16 v[120:121], v152 offset:28672
    v_mfma_f32_32x32x16_bf16 v[16:31], v[136:139], v[132:135], v[16:31]
    ds_read_b64_tr_b16 v[122:123], v152 offset:29696
    ds_read_b128 v[116:119], v147 offset:20480
    v_mfma_f32_32x32x16_bf16 v[32:47], v[140:143], v[128:131], v[32:47]
    ds_read_b64_tr_b16 v[124:125], v153 offset:28672
    ds_read_b64_tr_b16 v[126:127], v153 offset:29696
    v_mfma_f32_32x32x16_bf16 v[48:63], v[140:143], v[132:135], v[48:63]
    s_waitcnt lgkmcnt(9)
    v_mfma_f32_32x32x16_bf16 v[0:15], v[104:107], v[96:99], v[0:15]
    s_waitcnt lgkmcnt(0)
    s_barrier
    ds_read_b128 v[128:131], v144 offset:32768
    ds_read_b64_tr_b16 v[136:137], v152 offset:0
    v_mfma_f32_32x32x16_bf16 v[16:31], v[104:107], v[100:103], v[16:31]
    ds_read_b64_tr_b16 v[138:139], v152 offset:1024
    ds_read_b128 v[132:135], v144 offset:36864
    v_mfma_f32_32x32x16_bf16 v[32:47], v[108:111], v[96:99], v[32:47]
    ds_read_b64_tr_b16 v[140:141], v153 offset:0
    ds_read_b64_tr_b16 v[142:143], v153 offset:1024
    v_mfma_f32_32x32x16_bf16 v[48:63], v[108:111], v[100:103], v[48:63]
    v_mfma_f32_32x32x16_bf16 v[0:15], v[120:123], v[112:115], v[0:15]
    ds_read_b128 v[96:99], v145 offset:32768
    ds_read_b64_tr_b16 v[104:105], v152 offset:4096
    v_mfma_f32_32x32x16_bf16 v[16:31], v[120:123], v[116:119], v[16:31]
    ds_read_b64_tr_b16 v[106:107], v152 offset:5120
    ds_read_b128 v[100:103], v145 offset:36864
    v_mfma_f32_32x32x16_bf16 v[32:47], v[124:127], v[112:115], v[32:47]
    ds_read_b64_tr_b16 v[108:109], v153 offset:4096
    ds_read_b64_tr_b16 v[110:111], v153 offset:5120
    v_mfma_f32_32x32x16_bf16 v[48:63], v[124:127], v[116:119], v[48:63]
    s_waitcnt lgkmcnt(9)
    v_mfma_f32_32x32x16_bf16 v[0:15], v[136:139], v[128:131], v[0:15]
    s_waitcnt lgkmcnt(0)
    s_barrier
    ds_read_b128 v[112:115], v146 offset:32768
    ds_read_b64_tr_b16 v[120:121], v152 offset:8192
    v_mfma_f32_32x32x16_bf16 v[16:31], v[136:139], v[132:135], v[16:31]
    ds_read_b64_tr_b16 v[122:123], v152 offset:9216
    ds_read_b128 v[116:119], v146 offset:36864
    v_mfma_f32_32x32x16_bf16 v[32:47], v[140:143], v[128:131], v[32:47]
    ds_read_b64_tr_b16 v[124:125], v153 offset:8192
    ds_read_b64_tr_b16 v[126:127], v153 offset:9216
    v_mfma_f32_32x32x16_bf16 v[48:63], v[140:143], v[132:135], v[48:63]
    v_mfma_f32_32x32x16_bf16 v[0:15], v[104:107], v[96:99], v[0:15]
    ds_read_b128 v[128:131], v147 offset:32768
    ds_read_b64_tr_b16 v[136:137], v152 offset:12288
    v_mfma_f32_32x32x16_bf16 v[16:31], v[104:107], v[100:103], v[16:31]
    ds_read_b64_tr_b16 v[138:139], v152 offset:13312
    ds_read_b128 v[132:135], v147 offset:36864
    v_mfma_f32_32x32x16_bf16 v[32:47], v[108:111], v[96:99], v[32:47]
    ds_read_b64_tr_b16 v[140:141], v153 offset:12288
    ds_read_b64_tr_b16 v[142:143], v153 offset:13312
    v_mfma_f32_32x32x16_bf16 v[48:63], v[108:111], v[100:103], v[48:63]
    s_waitcnt lgkmcnt(9)
    v_mfma_f32_32x32x16_bf16 v[0:15], v[120:123], v[112:115], v[0:15]
    s_waitcnt lgkmcnt(0)
    s_barrier
    ds_read_b128 v[96:99], v144 offset:49152
    ds_read_b64_tr_b16 v[104:105], v152 offset:16384
    v_mfma_f32_32x32x16_bf16 v[16:31], v[120:123], v[116:119], v[16:31]
    ds_read_b64_tr_b16 v[106:107], v152 offset:17408
    ds_read_b128 v[100:103], v144 offset:53248
    v_mfma_f32_32x32x16_bf16 v[32:47], v[124:127], v[112:115], v[32:47]
    ds_read_b64_tr_b16 v[108:109], v153 offset:16384
    ds_read_b64_tr_b16 v[110:111], v153 offset:17408
    v_mfma_f32_32x32x16_bf16 v[48:63], v[124:127], v[116:119], v[48:63]
    v_mfma_f32_32x32x16_bf16 v[0:15], v[136:139], v[128:131], v[0:15]
    ds_read_b128 v[112:115], v145 offset:49152
    ds_read_b64_tr_b16 v[120:121], v152 offset:20480
    v_mfma_f32_32x32x16_bf16 v[16:31], v[136:139], v[132:135], v[16:31]
    ds_read_b64_tr_b16 v[122:123], v152 offset:21504
    ds_read_b128 v[116:119], v145 offset:53248
    v_mfma_f32_32x32x16_bf16 v[32:47], v[140:143], v[128:131], v[32:47]
    ds_read_b64_tr_b16 v[124:125], v153 offset:20480
    ds_read_b64_tr_b16 v[126:127], v153 offset:21504
    v_mfma_f32_32x32x16_bf16 v[48:63], v[140:143], v[132:135], v[48:63]
    s_waitcnt lgkmcnt(9)
    v_mfma_f32_32x32x16_bf16 v[0:15], v[104:107], v[96:99], v[0:15]
    s_waitcnt lgkmcnt(0)
    s_barrier
    ds_read_b128 v[128:131], v146 offset:49152
    ds_read_b64_tr_b16 v[136:137], v152 offset:24576
    v_mfma_f32_32x32x16_bf16 v[16:31], v[104:107], v[100:103], v[16:31]
    ds_read_b64_tr_b16 v[138:139], v152 offset:25600
    ds_read_b128 v[132:135], v146 offset:53248
    v_mfma_f32_32x32x16_bf16 v[32:47], v[108:111], v[96:99], v[32:47]
    ds_read_b64_tr_b16 v[140:141], v153 offset:24576
    ds_read_b64_tr_b16 v[142:143], v153 offset:25600
    v_mfma_f32_32x32x16_bf16 v[48:63], v[108:111], v[100:103], v[48:63]
    v_mfma_f32_32x32x16_bf16 v[0:15], v[120:123], v[112:115], v[0:15]
    ds_read_b128 v[96:99], v147 offset:49152
    ds_read_b64_tr_b16 v[104:105], v152 offset:28672
    v_mfma_f32_32x32x16_bf16 v[16:31], v[120:123], v[116:119], v[16:31]
    ds_read_b64_tr_b16 v[106:107], v152 offset:29696
    ds_read_b128 v[100:103], v147 offset:53248
    v_mfma_f32_32x32x16_bf16 v[32:47], v[124:127], v[112:115], v[32:47]
    ds_read_b64_tr_b16 v[108:109], v153 offset:28672
    ds_read_b64_tr_b16 v[110:111], v153 offset:29696
    v_mfma_f32_32x32x16_bf16 v[48:63], v[124:127], v[116:119], v[48:63]
    s_waitcnt lgkmcnt(9)
    v_mfma_f32_32x32x16_bf16 v[0:15], v[136:139], v[128:131], v[0:15]
    s_waitcnt lgkmcnt(0)
    s_barrier
    ds_read_b128 v[112:115], v148 offset:0
    ds_read_b64_tr_b16 v[120:121], v152 offset:0
    v_mfma_f32_32x32x16_bf16 v[16:31], v[136:139], v[132:135], v[16:31]
    ds_read_b64_tr_b16 v[122:123], v152 offset:1024
    ds_read_b128 v[116:119], v148 offset:4096
    v_mfma_f32_32x32x16_bf16 v[32:47], v[140:143], v[128:131], v[32:47]
    ds_read_b64_tr_b16 v[124:125], v153 offset:0
    ds_read_b64_tr_b16 v[126:127], v153 offset:1024
    v_mfma_f32_32x32x16_bf16 v[48:63], v[140:143], v[132:135], v[48:63]
    v_mfma_f32_32x32x16_bf16 v[0:15], v[104:107], v[96:99], v[0:15]
    ds_read_b128 v[128:131], v149 offset:0
    ds_read_b64_tr_b16 v[136:137], v152 offset:4096
    v_mfma_f32_32x32x16_bf16 v[16:31], v[104:107], v[100:103], v[16:31]
    ds_read_b64_tr_b16 v[138:139], v152 offset:5120
    ds_read_b128 v[132:135], v149 offset:4096
    v_mfma_f32_32x32x16_bf16 v[32:47], v[108:111], v[96:99], v[32:47]
    ds_read_b64_tr_b16 v[140:141], v153 offset:4096
    ds_read_b64_tr_b16 v[142:143], v153 offset:5120
    v_mfma_f32_32x32x16_bf16 v[48:63], v[108:111], v[100:103], v[48:63]
    s_waitcnt lgkmcnt(9)
    v_mfma_f32_32x32x16_bf16 v[0:15], v[120:123], v[112:115], v[0:15]
    s_waitcnt lgkmcnt(0)
    s_barrier
    ds_read_b128 v[96:99], v150 offset:0
    ds_read_b64_tr_b16 v[104:105], v152 offset:8192
    v_mfma_f32_32x32x16_bf16 v[16:31], v[120:123], v[116:119], v[16:31]
    ds_read_b64_tr_b16 v[106:107], v152 offset:9216
    ds_read_b128 v[100:103], v150 offset:4096
    v_mfma_f32_32x32x16_bf16 v[32:47], v[124:127], v[112:115], v[32:47]
    ds_read_b64_tr_b16 v[108:109], v153 offset:8192
    ds_read_b64_tr_b16 v[110:111], v153 offset:9216
    v_mfma_f32_32x32x16_bf16 v[48:63], v[124:127], v[116:119], v[48:63]
    v_mfma_f32_32x32x16_bf16 v[0:15], v[136:139], v[128:131], v[0:15]
    ds_read_b128 v[112:115], v151 offset:0
    ds_read_b64_tr_b16 v[120:121], v152 offset:12288
    v_mfma_f32_32x32x16_bf16 v[16:31], v[136:139], v[132:135], v[16:31]
    ds_read_b64_tr_b16 v[122:123], v152 offset:13312
    ds_read_b128 v[116:119], v151 offset:4096
    v_mfma_f32_32x32x16_bf16 v[32:47], v[140:143], v[128:131], v[32:47]
    ds_read_b64_tr_b16 v[124:125], v153 offset:12288
    ds_read_b64_tr_b16 v[126:127], v153 offset:13312
    v_mfma_f32_32x32x16_bf16 v[48:63], v[140:143], v[132:135], v[48:63]
    s_waitcnt lgkmcnt(9)
    v_mfma_f32_32x32x16_bf16 v[0:15], v[104:107], v[96:99], v[0:15]
    s_waitcnt lgkmcnt(0)
    s_barrier
    ds_read_b128 v[128:131], v148 offset:16384
    ds_read_b64_tr_b16 v[136:137], v152 offset:16384
    v_mfma_f32_32x32x16_bf16 v[16:31], v[104:107], v[100:103], v[16:31]
    ds_read_b64_tr_b16 v[138:139], v152 offset:17408
    ds_read_b128 v[132:135], v148 offset:20480
    v_mfma_f32_32x32x16_bf16 v[32:47], v[108:111], v[96:99], v[32:47]
    ds_read_b64_tr_b16 v[140:141], v153 offset:16384
    ds_read_b64_tr_b16 v[142:143], v153 offset:17408
    v_mfma_f32_32x32x16_bf16 v[48:63], v[108:111], v[100:103], v[48:63]
    v_mfma_f32_32x32x16_bf16 v[0:15], v[120:123], v[112:115], v[0:15]
    ds_read_b128 v[96:99], v149 offset:16384
    ds_read_b64_tr_b16 v[104:105], v152 offset:20480
    v_mfma_f32_32x32x16_bf16 v[16:31], v[120:123], v[116:119], v[16:31]
    ds_read_b64_tr_b16 v[106:107], v152 offset:21504
    ds_read_b128 v[100:103], v149 offset:20480
    v_mfma_f32_32x32x16_bf16 v[32:47], v[124:127], v[112:115], v[32:47]
    ds_read_b64_tr_b16 v[108:109], v153 offset:20480
    ds_read_b64_tr_b16 v[110:111], v153 offset:21504
    v_mfma_f32_32x32x16_bf16 v[48:63], v[124:127], v[116:119], v[48:63]
    s_waitcnt lgkmcnt(9)
    v_mfma_f32_32x32x16_bf16 v[0:15], v[136:139], v[128:131], v[0:15]
    s_waitcnt lgkmcnt(0)
    s_barrier
    ds_read_b128 v[112:115], v150 offset:16384
    ds_read_b64_tr_b16 v[120:121], v152 offset:24576
    v_mfma_f32_32x32x16_bf16 v[16:31], v[136:139], v[132:135], v[16:31]
    ds_read_b64_tr_b16 v[122:123], v152 offset:25600
    ds_read_b128 v[116:119], v150 offset:20480
    v_mfma_f32_32x32x16_bf16 v[32:47], v[140:143], v[128:131], v[32:47]
    ds_read_b64_tr_b16 v[124:125], v153 offset:24576
    ds_read_b64_tr_b16 v[126:127], v153 offset:25600
    v_mfma_f32_32x32x16_bf16 v[48:63], v[140:143], v[132:135], v[48:63]
    v_mfma_f32_32x32x16_bf16 v[0:15], v[104:107], v[96:99], v[0:15]
    ds_read_b128 v[128:131], v151 offset:16384
    ds_read_b64_tr_b16 v[136:137], v152 offset:28672
    v_mfma_f32_32x32x16_bf16 v[16:31], v[104:107], v[100:103], v[16:31]
    ds_read_b64_tr_b16 v[138:139], v152 offset:29696
    ds_read_b128 v[132:135], v151 offset:20480
    v_mfma_f32_32x32x16_bf16 v[32:47], v[108:111], v[96:99], v[32:47]
    ds_read_b64_tr_b16 v[140:141], v153 offset:28672
    ds_read_b64_tr_b16 v[142:143], v153 offset:29696
    v_mfma_f32_32x32x16_bf16 v[48:63], v[108:111], v[100:103], v[48:63]
    s_waitcnt lgkmcnt(9)
    v_mfma_f32_32x32x16_bf16 v[0:15], v[120:123], v[112:115], v[0:15]
    s_waitcnt lgkmcnt(0)
    s_barrier
    ds_read_b128 v[96:99], v148 offset:32768
    ds_read_b64_tr_b16 v[104:105], v152 offset:0
    v_mfma_f32_32x32x16_bf16 v[16:31], v[120:123], v[116:119], v[16:31]
    ds_read_b64_tr_b16 v[106:107], v152 offset:1024
    ds_read_b128 v[100:103], v148 offset:36864
    v_mfma_f32_32x32x16_bf16 v[32:47], v[124:127], v[112:115], v[32:47]
    ds_read_b64_tr_b16 v[108:109], v153 offset:0
    ds_read_b64_tr_b16 v[110:111], v153 offset:1024
    v_mfma_f32_32x32x16_bf16 v[48:63], v[124:127], v[116:119], v[48:63]
    v_mfma_f32_32x32x16_bf16 v[0:15], v[136:139], v[128:131], v[0:15]
    ds_read_b128 v[112:115], v149 offset:32768
    ds_read_b64_tr_b16 v[120:121], v152 offset:4096
    v_mfma_f32_32x32x16_bf16 v[16:31], v[136:139], v[132:135], v[16:31]
    ds_read_b64_tr_b16 v[122:123], v152 offset:5120
    ds_read_b128 v[116:119], v149 offset:36864
    v_mfma_f32_32x32x16_bf16 v[32:47], v[140:143], v[128:131], v[32:47]
    ds_read_b64_tr_b16 v[124:125], v153 offset:4096
    ds_read_b64_tr_b16 v[126:127], v153 offset:5120
    v_mfma_f32_32x32x16_bf16 v[48:63], v[140:143], v[132:135], v[48:63]
    s_waitcnt lgkmcnt(9)
    v_mfma_f32_32x32x16_bf16 v[0:15], v[104:107], v[96:99], v[0:15]
    s_waitcnt lgkmcnt(0)
    s_barrier
    ds_read_b128 v[128:131], v150 offset:32768
    ds_read_b64_tr_b16 v[136:137], v152 offset:8192
    v_mfma_f32_32x32x16_bf16 v[16:31], v[104:107], v[100:103], v[16:31]
    ds_read_b64_tr_b16 v[138:139], v152 offset:9216
    ds_read_b128 v[132:135], v150 offset:36864
    v_mfma_f32_32x32x16_bf16 v[32:47], v[108:111], v[96:99], v[32:47]
    ds_read_b64_tr_b16 v[140:141], v153 offset:8192
    ds_read_b64_tr_b16 v[142:143], v153 offset:9216
    v_mfma_f32_32x32x16_bf16 v[48:63], v[108:111], v[100:103], v[48:63]
    v_mfma_f32_32x32x16_bf16 v[0:15], v[120:123], v[112:115], v[0:15]
    ds_read_b128 v[96:99], v151 offset:32768
    ds_read_b64_tr_b16 v[104:105], v152 offset:12288
    v_mfma_f32_32x32x16_bf16 v[16:31], v[120:123], v[116:119], v[16:31]
    ds_read_b64_tr_b16 v[106:107], v152 offset:13312
    ds_read_b128 v[100:103], v151 offset:36864
    v_mfma_f32_32x32x16_bf16 v[32:47], v[124:127], v[112:115], v[32:47]
    ds_read_b64_tr_b16 v[108:109], v153 offset:12288
    ds_read_b64_tr_b16 v[110:111], v153 offset:13312
    v_mfma_f32_32x32x16_bf16 v[48:63], v[124:127], v[116:119], v[48:63]
    s_waitcnt lgkmcnt(9)
    v_mfma_f32_32x32x16_bf16 v[0:15], v[136:139], v[128:131], v[0:15]
    s_waitcnt lgkmcnt(0)
    s_barrier
    ds_read_b128 v[112:115], v148 offset:49152
    ds_read_b64_tr_b16 v[120:121], v152 offset:16384
    v_mfma_f32_32x32x16_bf16 v[16:31], v[136:139], v[132:135], v[16:31]
    ds_read_b64_tr_b16 v[122:123], v152 offset:17408
    ds_read_b128 v[116:119], v148 offset:53248
    v_mfma_f32_32x32x16_bf16 v[32:47], v[140:143], v[128:131], v[32:47]
    ds_read_b64_tr_b16 v[124:125], v153 offset:16384
    ds_read_b64_tr_b16 v[126:127], v153 offset:17408
    v_mfma_f32_32x32x16_bf16 v[48:63], v[140:143], v[132:135], v[48:63]
    v_mfma_f32_32x32x16_bf16 v[0:15], v[104:107], v[96:99], v[0:15]
    ds_read_b128 v[128:131], v149 offset:49152
    ds_read_b64_tr_b16 v[136:137], v152 offset:20480
    v_mfma_f32_32x32x16_bf16 v[16:31], v[104:107], v[100:103], v[16:31]
    ds_read_b64_tr_b16 v[138:139], v152 offset:21504
    ds_read_b128 v[132:135], v149 offset:53248
    v_mfma_f32_32x32x16_bf16 v[32:47], v[108:111], v[96:99], v[32:47]
    ds_read_b64_tr_b16 v[140:141], v153 offset:20480
    ds_read_b64_tr_b16 v[142:143], v153 offset:21504
    v_mfma_f32_32x32x16_bf16 v[48:63], v[108:111], v[100:103], v[48:63]
    s_waitcnt lgkmcnt(9)
    v_mfma_f32_32x32x16_bf16 v[0:15], v[120:123], v[112:115], v[0:15]
    s_waitcnt lgkmcnt(0)
    s_barrier
    ds_read_b128 v[96:99], v150 offset:49152
    ds_read_b64_tr_b16 v[104:105], v152 offset:24576
    v_mfma_f32_32x32x16_bf16 v[16:31], v[120:123], v[116:119], v[16:31]
    ds_read_b64_tr_b16 v[106:107], v152 offset:25600
    ds_read_b128 v[100:103], v150 offset:53248
    v_mfma_f32_32x32x16_bf16 v[32:47], v[124:127], v[112:115], v[32:47]
    ds_read_b64_tr_b16 v[108:109], v153 offset:24576
    ds_read_b64_tr_b16 v[110:111], v153 offset:25600
    v_mfma_f32_32x32x16_bf16 v[48:63], v[124:127], v[116:119], v[48:63]
    v_mfma_f32_32x32x16_bf16 v[0:15], v[136:139], v[128:131], v[0:15]
    ds_read_b128 v[112:115], v151 offset:49152
    ds_read_b64_tr_b16 v[120:121], v152 offset:28672
    v_mfma_f32_32x32x16_bf16 v[16:31], v[136:139], v[132:135], v[16:31]
    ds_read_b64_tr_b16 v[122:123], v152 offset:29696
    ds_read_b128 v[116:119], v151 offset:53248
    v_mfma_f32_32x32x16_bf16 v[32:47], v[140:143], v[128:131], v[32:47]
    ds_read_b64_tr_b16 v[124:125], v153 offset:28672
    ds_read_b64_tr_b16 v[126:127], v153 offset:29696
    v_mfma_f32_32x32x16_bf16 v[48:63], v[140:143], v[132:135], v[48:63]
    s_waitcnt lgkmcnt(9)
    v_mfma_f32_32x32x16_bf16 v[0:15], v[104:107], v[96:99], v[0:15]
    s_waitcnt lgkmcnt(0)
    s_barrier
    ds_read_b128 v[128:131], v144 offset:0
    ds_read_b64_tr_b16 v[136:137], v154 offset:0
    v_mfma_f32_32x32x16_bf16 v[16:31], v[104:107], v[100:103], v[16:31]
    ds_read_b64_tr_b16 v[138:139], v154 offset:512
    ds_read_b128 v[132:135], v144 offset:4096
    v_mfma_f32_32x32x16_bf16 v[32:47], v[108:111], v[96:99], v[32:47]
    v_mfma_f32_32x32x16_bf16 v[48:63], v[108:111], v[100:103], v[48:63]
    v_mfma_f32_32x32x16_bf16 v[0:15], v[120:123], v[112:115], v[0:15]
    ds_read_b128 v[96:99], v145 offset:0
    ds_read_b64_tr_b16 v[104:105], v154 offset:2048
    v_mfma_f32_32x32x16_bf16 v[16:31], v[120:123], v[116:119], v[16:31]
    ds_read_b64_tr_b16 v[106:107], v154 offset:2560
    ds_read_b128 v[100:103], v145 offset:4096
    v_mfma_f32_32x32x16_bf16 v[32:47], v[124:127], v[112:115], v[32:47]
    v_mfma_f32_32x32x16_bf16 v[48:63], v[124:127], v[116:119], v[48:63]
    s_cmp_eq_u32 s59, 7
    s_cbranch_scc1 L_f_gate
    s_waitcnt lgkmcnt(5)
    v_mfma_f32_32x32x16_bf16 v[64:79], v[136:139], v[128:131], 0
    ds_read_b128 v[112:115], v146 offset:0
    ds_read_b64_tr_b16 v[120:121], v154 offset:4096
    s_waitcnt lgkmcnt(6)
    v_mfma_f32_32x32x16_bf16 v[80:95], v[136:139], v[132:135], 0
    ds_read_b64_tr_b16 v[122:123], v154 offset:4608
    ds_read_b128 v[116:119], v146 offset:4096
    s_waitcnt lgkmcnt(5)
    v_mfma_f32_32x32x16_bf16 v[64:79], v[104:107], v[96:99], v[64:79]
    ds_read_b128 v[128:131], v147 offset:0
    ds_read_b64_tr_b16 v[136:137], v154 offset:6144
    s_nop 7
    v_mul_f32 v240, s70, v0
    v_mul_f32 v241, s70, v1
    v_mul_f32 v242, s70, v2
    v_mul_f32 v243, s70, v3
    v_mul_f32 v244, s70, v4
    s_waitcnt lgkmcnt(6)
    v_mfma_f32_32x32x16_bf16 v[80:95], v[104:107], v[100:103], v[80:95]
    ds_read_b64_tr_b16 v[138:139], v154 offset:6656
    ds_read_b128 v[132:135], v147 offset:4096
    v_mul_f32 v245, s70, v5
    v_mul_f32 v246, s70, v6
    v_mul_f32 v247, s70, v7
    v_exp_f32 v240, v240
    v_exp_f32 v241, v241
    v_exp_f32 v242, v242
    s_waitcnt lgkmcnt(5)
    v_mfma_f32_32x32x16_bf16 v[64:79], v[120:123], v[112:115], v[64:79]
    s_waitcnt lgkmcnt(0)
    s_barrier
    ds_read_b128 v[96:99], v144 offset:16384
    ds_read_b64_tr_b16 v[104:105], v154 offset:8192
    v_exp_f32 v243, v243
    v_exp_f32 v244, v244
    v_exp_f32 v245, v245
    v_exp_f32 v246, v246
    v_exp_f32 v247, v247
    v_add_f32 v240, 1.0, v240
    v_mfma_f32_32x32x16_bf16 v[80:95], v[120:123], v[116:119], v[80:95]
    ds_read_b64_tr_b16 v[106:107], v154 offset:8704
    ds_read_b128 v[100:103], v144 offset:20480
    v_add_f32 v241, 1.0, v241
    v_add_f32 v242, 1.0, v242
    v_add_f32 v243, 1.0, v243
    v_add_f32 v244, 1.0, v244
    v_add_f32 v245, 1.0, v245
    v_add_f32 v246, 1.0, v246
    v_mfma_f32_32x32x16_bf16 v[64:79], v[136:139], v[128:131], v[64:79]
    ds_read_b128 v[112:115], v145 offset:16384
    ds_read_b64_tr_b16 v[120:121], v154 offset:10240
    v_add_f32 v247, 1.0, v247
    v_rcp_f32 v240, v240
    v_rcp_f32 v241, v241
    v_rcp_f32 v242, v242
    v_rcp_f32 v243, v243
    v_rcp_f32 v244, v244
    v_mfma_f32_32x32x16_bf16 v[80:95], v[136:139], v[132:135], v[80:95]
    ds_read_b64_tr_b16 v[122:123], v154 offset:10752
    ds_read_b128 v[116:119], v145 offset:20480
    v_rcp_f32 v245, v245
    v_rcp_f32 v246, v246
    v_rcp_f32 v247, v247
    v_mul_f32 v240, v240, v0
    v_mul_f32 v241, v241, v1
    v_mul_f32 v242, v242, v2
    s_waitcnt lgkmcnt(5)
    v_mfma_f32_32x32x16_bf16 v[64:79], v[104:107], v[96:99], v[64:79]
    ds_read_b128 v[128:131], v146 offset:16384
    ds_read_b64_tr_b16 v[136:137], v154 offset:12288
    v_mul_f32 v243, v243, v3
    v_mul_f32 v244, v244, v4
    v_mul_f32 v245, v245, v5
    v_mul_f32 v246, v246, v6
    v_mul_f32 v247, v247, v7
    v_cvt_pk_bf16_f32 v0, v240, v241
    s_waitcnt lgkmcnt(6)
    v_mfma_f32_32x32x16_bf16 v[80:95], v[104:107], v[100:103], v[80:95]
    ds_read_b64_tr_b16 v[138:139], v154 offset:12800
    ds_read_b128 v[132:135], v146 offset:20480
    v_cvt_pk_bf16_f32 v1, v242, v243
    v_cvt_pk_bf16_f32 v2, v244, v245
    v_cvt_pk_bf16_f32 v3, v246, v247
    buffer_store_dwordx4 v[0:3], v233, s[20:23], s72 offen sc1
    v_mul_f32 v240, s70, v8
    v_mul_f32 v241, s70, v9
    s_waitcnt lgkmcnt(5)
    v_mfma_f32_32x32x16_bf16 v[64:79], v[120:123], v[112:115], v[64:79]
    ds_read_b128 v[96:99], v147 offset:16384
    ds_read_b64_tr_b16 v[104:105], v154 offset:14336
    v_mul_f32 v242, s70, v10
    v_mul_f32 v243, s70, v11
    v_mul_f32 v244, s70, v12
    v_mul_f32 v245, s70, v13
    v_mul_f32 v246, s70, v14
    v_mul_f32 v247, s70, v15
    s_waitcnt lgkmcnt(6)
    v_mfma_f32_32x32x16_bf16 v[80:95], v[120:123], v[116:119], v[80:95]
    ds_read_b64_tr_b16 v[106:107], v154 offset:14848
    ds_read_b128 v[100:103], v147 offset:20480
    v_exp_f32 v240, v240
    v_exp_f32 v241, v241
    v_exp_f32 v242, v242
    v_exp_f32 v243, v243
    v_exp_f32 v244, v244
    v_exp_f32 v245, v245
    s_waitcnt lgkmcnt(5)
    v_mfma_f32_32x32x16_bf16 v[64:79], v[136:139], v[128:131], v[64:79]
    s_waitcnt lgkmcnt(0)
    s_barrier
    ds_read_b128 v[112:115], v144 offset:32768
    ds_read_b64_tr_b16 v[120:121], v154 offset:16384
    v_exp_f32 v246, v246
    v_exp_f32 v247, v247
    v_add_f32 v240, 1.0, v240
    v_add_f32 v241, 1.0, v241
    v_add_f32 v242, 1.0, v242
    v_add_f32 v243, 1.0, v243
    v_mfma_f32_32x32x16_bf16 v[80:95], v[136:139], v[132:135], v[80:95]
    ds_read_b64_tr_b16 v[122:123], v154 offset:16896
    ds_read_b128 v[116:119], v144 offset:36864
    v_add_f32 v244, 1.0, v244
    v_add_f32 v245, 1.0, v245
    v_add_f32 v246, 1.0, v246
    v_add_f32 v247, 1.0, v247
    v_rcp_f32 v240, v240
    v_rcp_f32 v241, v241
    v_mfma_f32_32x32x16_bf16 v[64:79], v[104:107], v[96:99], v[64:79]
    ds_read_b128 v[128:131], v145 offset:32768
    ds_read_b64_tr_b16 v[136:137], v154 offset:18432
    v_rcp_f32 v242, v242
    v_rcp_f32 v243, v243
    v_rcp_f32 v244, v244
    v_rcp_f32 v245, v245
    v_rcp_f32 v246, v246
    v_rcp_f32 v247, v247
    v_mfma_f32_32x32x16_bf16 v[80:95], v[104:107], v[100:103], v[80:95]
    ds_read_b64_tr_b16 v[138:139], v154 offset:18944
    ds_read_b128 v[132:135], v145 offset:36864
    v_mul_f32 v240, v240, v8
    v_mul_f32 v241, v241, v9
    v_mul_f32 v242, v242, v10
    v_mul_f32 v243, v243, v11
    v_mul_f32 v244, v244, v12
    v_mul_f32 v245, v245, v13
    s_waitcnt lgkmcnt(5)
    v_mfma_f32_32x32x16_bf16 v[64:79], v[120:123], v[112:115], v[64:79]
    ds_read_b128 v[96:99], v146 offset:32768
    ds_read_b64_tr_b16 v[104:105], v154 offset:20480
    v_mul_f32 v246, v246, v14
    v_mul_f32 v247, v247, v15
    v_cvt_pk_bf16_f32 v8, v240, v241
    v_cvt_pk_bf16_f32 v9, v242, v243
    v_cvt_pk_bf16_f32 v10, v244, v245
    v_cvt_pk_bf16_f32 v11, v246, v247
    s_waitcnt lgkmcnt(6)
    v_mfma_f32_32x32x16_bf16 v[80:95], v[120:123], v[116:119], v[80:95]
    ds_read_b64_tr_b16 v[106:107], v154 offset:20992
    ds_read_b128 v[100:103], v146 offset:36864
    buffer_store_dwordx4 v[8:11], v233, s[20:23], s73 offen sc1
    v_mul_f32 v240, s70, v16
    v_mul_f32 v241, s70, v17
    v_mul_f32 v242, s70, v18
    v_mul_f32 v243, s70, v19
    v_mul_f32 v244, s70, v20
    s_waitcnt lgkmcnt(5)
    v_mfma_f32_32x32x16_bf16 v[64:79], v[136:139], v[128:131], v[64:79]
    ds_read_b128 v[112:115], v147 offset:32768
    ds_read_b64_tr_b16 v[120:121], v154 offset:22528
    v_mul_f32 v245, s70, v21
    v_mul_f32 v246, s70, v22
    v_mul_f32 v247, s70, v23
    v_exp_f32 v240, v240
    v_exp_f32 v241, v241
    v_exp_f32 v242, v242
    s_waitcnt lgkmcnt(6)
    v_mfma_f32_32x32x16_bf16 v[80:95], v[136:139], v[132:135], v[80:95]
    ds_read_b64_tr_b16 v[122:123], v154 offset:23040
    ds_read_b128 v[116:119], v147 offset:36864
    v_exp_f32 v243, v243
    v_exp_f32 v244, v244
    v_exp_f32 v245, v245
    v_exp_f32 v246, v246
    v_exp_f32 v247, v247
    v_add_f32 v240, 1.0, v240
    s_waitcnt lgkmcnt(5)
    v_mfma_f32_32x32x16_bf16 v[64:79], v[104:107], v[96:99], v[64:79]
    s_waitcnt lgkmcnt(0)
    s_barrier
    ds_read_b128 v[128:131], v144 offset:49152
    ds_read_b64_tr_b16 v[136:137], v154 offset:24576
    v_add_f32 v241, 1.0, v241
    v_add_f32 v242, 1.0, v242
    v_add_f32 v243, 1.0, v243
    v_add_f32 v244, 1.0, v244
    v_add_f32 v245, 1.0, v245
    v_add_f32 v246, 1.0, v246
    v_mfma_f32_32x32x16_bf16 v[80:95], v[104:107], v[100:103], v[80:95]
    ds_read_b64_tr_b16 v[138:139], v154 offset:25088
    ds_read_b128 v[132:135], v144 offset:53248
    v_add_f32 v247, 1.0, v247
    v_rcp_f32 v240, v240
    v_rcp_f32 v241, v241
    v_rcp_f32 v242, v242
    v_rcp_f32 v243, v243
    v_rcp_f32 v244, v244
    v_mfma_f32_32x32x16_bf16 v[64:79], v[120:123], v[112:115], v[64:79]
    ds_read_b128 v[96:99], v145 offset:49152
    ds_read_b64_tr_b16 v[104:105], v154 offset:26624
    v_rcp_f32 v245, v245
    v_rcp_f32 v246, v246
    v_rcp_f32 v247, v247
    v_mul_f32 v240, v240, v16
    v_mul_f32 v241, v241, v17
    v_mul_f32 v242, v242, v18
    v_mfma_f32_32x32x16_bf16 v[80:95], v[120:123], v[116:119], v[80:95]
    ds_read_b64_tr_b16 v[106:107], v154 offset:27136
    ds_read_b128 v[100:103], v145 offset:53248
    v_mul_f32 v243, v243, v19
    v_mul_f32 v244, v244, v20
    v_mul_f32 v245, v245, v21
    v_mul_f32 v246, v246, v22
    v_mul_f32 v247, v247, v23
    v_cvt_pk_bf16_f32 v16, v240, v241
    s_waitcnt lgkmcnt(5)
    v_mfma_f32_32x32x16_bf16 v[64:79], v[136:139], v[128:131], v[64:79]
    ds_read_b128 v[112:115], v146 offset:49152
    ds_read_b64_tr_b16 v[120:121], v154 offset:28672
    v_cvt_pk_bf16_f32 v17, v242, v243
    v_cvt_pk_bf16_f32 v18, v244, v245
    v_cvt_pk_bf16_f32 v19, v246, v247
    buffer_store_dwordx4 v[16:19], v233, s[20:23], s74 offen sc1
    v_mul_f32 v240, s70, v24
    v_mul_f32 v241, s70, v25
    s_waitcnt lgkmcnt(6)
    v_mfma_f32_32x32x16_bf16 v[80:95], v[136:139], v[132:135], v[80:95]
    ds_read_b64_tr_b16 v[122:123], v154 offset:29184
    ds_read_b128 v[116:119], v146 offset:53248
    v_mul_f32 v242, s70, v26
    v_mul_f32 v243, s70, v27
    v_mul_f32 v244, s70, v28
    v_mul_f32 v245, s70, v29
    v_mul_f32 v246, s70, v30
    v_mul_f32 v247, s70, v31
    s_waitcnt lgkmcnt(5)
    v_mfma_f32_32x32x16_bf16 v[64:79], v[104:107], v[96:99], v[64:79]
    ds_read_b128 v[128:131], v147 offset:49152
    ds_read_b64_tr_b16 v[136:137], v154 offset:30720
    v_exp_f32 v240, v240
    v_exp_f32 v241, v241
    v_exp_f32 v242, v242
    v_exp_f32 v243, v243
    v_exp_f32 v244, v244
    v_exp_f32 v245, v245
    s_waitcnt lgkmcnt(6)
    v_mfma_f32_32x32x16_bf16 v[80:95], v[104:107], v[100:103], v[80:95]
    ds_read_b64_tr_b16 v[138:139], v154 offset:31232
    ds_read_b128 v[132:135], v147 offset:53248
    v_exp_f32 v246, v246
    v_exp_f32 v247, v247
    v_add_f32 v240, 1.0, v240
    v_add_f32 v241, 1.0, v241
    v_add_f32 v242, 1.0, v242
    v_add_f32 v243, 1.0, v243
    s_waitcnt lgkmcnt(5)
    v_mfma_f32_32x32x16_bf16 v[64:79], v[120:123], v[112:115], v[64:79]
    s_waitcnt lgkmcnt(0)
    s_barrier
    ds_read_b128 v[96:99], v148 offset:0
    ds_read_b64_tr_b16 v[104:105], v154 offset:0
    v_add_f32 v244, 1.0, v244
    v_add_f32 v245, 1.0, v245
    v_add_f32 v246, 1.0, v246
    v_add_f32 v247, 1.0, v247
    v_rcp_f32 v240, v240
    v_rcp_f32 v241, v241
    v_mfma_f32_32x32x16_bf16 v[80:95], v[120:123], v[116:119], v[80:95]
    ds_read_b64_tr_b16 v[106:107], v154 offset:512
    ds_read_b128 v[100:103], v148 offset:4096
    v_rcp_f32 v242, v242
    v_rcp_f32 v243, v243
    v_rcp_f32 v244, v244
    v_rcp_f32 v245, v245
    v_rcp_f32 v246, v246
    v_rcp_f32 v247, v247
    v_mfma_f32_32x32x16_bf16 v[64:79], v[136:139], v[128:131], v[64:79]
    ds_read_b128 v[112:115], v149 offset:0
    ds_read_b64_tr_b16 v[120:121], v154 offset:2048
    v_mul_f32 v240, v240, v24
    v_mul_f32 v241, v241, v25
    v_mul_f32 v242, v242, v26
    v_mul_f32 v243, v243, v27
    v_mul_f32 v244, v244, v28
    v_mul_f32 v245, v245, v29
    v_mfma_f32_32x32x16_bf16 v[80:95], v[136:139], v[132:135], v[80:95]
    ds_read_b64_tr_b16 v[122:123], v154 offset:2560
    ds_read_b128 v[116:119], v149 offset:4096
    v_mul_f32 v246, v246, v30
    v_mul_f32 v247, v247, v31
    v_cvt_pk_bf16_f32 v24, v240, v241
    v_cvt_pk_bf16_f32 v25, v242, v243
    v_cvt_pk_bf16_f32 v26, v244, v245
    v_cvt_pk_bf16_f32 v27, v246, v247
    s_waitcnt lgkmcnt(5)
    v_mfma_f32_32x32x16_bf16 v[64:79], v[104:107], v[96:99], v[64:79]
    ds_read_b128 v[128:131], v150 offset:0
    ds_read_b64_tr_b16 v[136:137], v154 offset:4096
    buffer_store_dwordx4 v[24:27], v233, s[20:23], s75 offen sc1
    v_mul_f32 v240, s70, v32
    v_mul_f32 v241, s70, v33
    v_mul_f32 v242, s70, v34
    v_mul_f32 v243, s70, v35
    v_mul_f32 v244, s70, v36
    s_waitcnt lgkmcnt(6)
    v_mfma_f32_32x32x16_bf16 v[80:95], v[104:107], v[100:103], v[80:95]
    ds_read_b64_tr_b16 v[138:139], v154 offset:4608
    ds_read_b128 v[132:135], v150 offset:4096
    v_mul_f32 v245, s70, v37
    v_mul_f32 v246, s70, v38
    v_mul_f32 v247, s70, v39
    v_exp_f32 v240, v240
    v_exp_f32 v241, v241
    v_exp_f32 v242, v242
    s_waitcnt lgkmcnt(5)
    v_mfma_f32_32x32x16_bf16 v[64:79], v[120:123], v[112:115], v[64:79]
    ds_read_b128 v[96:99], v151 offset:0
    ds_read_b64_tr_b16 v[104:105], v154 offset:6144
    v_exp_f32 v243, v243
    v_exp_f32 v244, v244
    v_exp_f32 v245, v245
    v_exp_f32 v246, v246
    v_exp_f32 v247, v247
    v_add_f32 v240, 1.0, v240
    s_waitcnt lgkmcnt(6)
    v_mfma_f32_32x32x16_bf16 v[80:95], v[120:123], v[116:119], v[80:95]
    ds_read_b64_tr_b16 v[106:107], v154 offset:6656
    ds_read_b128 v[100:103], v151 offset:4096
    v_add_f32 v241, 1.0, v241
    v_add_f32 v242, 1.0, v242
    v_add_f32 v243, 1.0, v243
    v_add_f32 v244, 1.0, v244
    v_add_f32 v245, 1.0, v245
    v_add_f32 v246, 1.0, v246
    s_waitcnt lgkmcnt(5)
    v_mfma_f32_32x32x16_bf16 v[64:79], v[136:139], v[128:131], v[64:79]
    ds_read_b128 v[112:115], v148 offset:16384
    ds_read_b64_tr_b16 v[120:121], v154 offset:8192
    v_add_f32 v247, 1.0, v247
    v_rcp_f32 v240, v240
    v_rcp_f32 v241, v241
    v_rcp_f32 v242, v242
    v_rcp_f32 v243, v243
    v_rcp_f32 v244, v244
    s_waitcnt lgkmcnt(6)
    v_mfma_f32_32x32x16_bf16 v[80:95], v[136:139], v[132:135], v[80:95]
    ds_read_b64_tr_b16 v[122:123], v154 offset:8704
    ds_read_b128 v[116:119], v148 offset:20480
    v_rcp_f32 v245, v245
    v_rcp_f32 v246, v246
    v_rcp_f32 v247, v247
    v_mul_f32 v240, v240, v32
    v_mul_f32 v241, v241, v33
    v_mul_f32 v242, v242, v34
    s_waitcnt lgkmcnt(5)
    v_mfma_f32_32x32x16_bf16 v[64:79], v[104:107], v[96:99], v[64:79]
    ds_read_b128 v[128:131], v149 offset:16384
    ds_read_b64_tr_b16 v[136:137], v154 offset:10240
    v_mul_f32 v243, v243, v35
    v_mul_f32 v244, v244, v36
    v_mul_f32 v245, v245, v37
    v_mul_f32 v246, v246, v38
    v_mul_f32 v247, v247, v39
    v_cvt_pk_bf16_f32 v32, v240, v241
    s_waitcnt lgkmcnt(6)
    v_mfma_f32_32x32x16_bf16 v[80:95], v[104:107], v[100:103], v[80:95]
    ds_read_b64_tr_b16 v[138:139], v154 offset:10752
    ds_read_b128 v[132:135], v149 offset:20480
    v_cvt_pk_bf16_f32 v33, v242, v243
    v_cvt_pk_bf16_f32 v34, v244, v245
    v_cvt_pk_bf16_f32 v35, v246, v247
    buffer_store_dwordx4 v[32:35], v234, s[20:23], s72 offen sc1
    v_mul_f32 v240, s70, v40
    v_mul_f32 v241, s70, v41
    s_waitcnt lgkmcnt(5)
    v_mfma_f32_32x32x16_bf16 v[64:79], v[120:123], v[112:115], v[64:79]
    ds_read_b128 v[96:99], v150 offset:16384
    ds_read_b64_tr_b16 v[104:105], v154 offset:12288
    v_mul_f32 v242, s70, v42
    v_mul_f32 v243, s70, v43
    v_mul_f32 v244, s70, v44
    v_mul_f32 v245, s70, v45
    v_mul_f32 v246, s70, v46
    v_mul_f32 v247, s70, v47
    s_waitcnt lgkmcnt(6)
    v_mfma_f32_32x32x16_bf16 v[80:95], v[120:123], v[116:119], v[80:95]
    ds_read_b64_tr_b16 v[106:107], v154 offset:12800
    ds_read_b128 v[100:103], v150 offset:20480
    v_exp_f32 v240, v240
    v_exp_f32 v241, v241
    v_exp_f32 v242, v242
    v_exp_f32 v243, v243
    v_exp_f32 v244, v244
    v_exp_f32 v245, v245
    s_waitcnt lgkmcnt(5)
    v_mfma_f32_32x32x16_bf16 v[64:79], v[136:139], v[128:131], v[64:79]
    ds_read_b128 v[112:115], v151 offset:16384
    ds_read_b64_tr_b16 v[120:121], v154 offset:14336
    v_exp_f32 v246, v246
    v_exp_f32 v247, v247
    v_add_f32 v240, 1.0, v240
    v_add_f32 v241, 1.0, v241
    v_add_f32 v242, 1.0, v242
    v_add_f32 v243, 1.0, v243
    s_waitcnt lgkmcnt(6)
    v_mfma_f32_32x32x16_bf16 v[80:95], v[136:139], v[132:135], v[80:95]
    ds_read_b64_tr_b16 v[122:123], v154 offset:14848
    ds_read_b128 v[116:119], v151 offset:20480
    v_add_f32 v244, 1.0, v244
    v_add_f32 v245, 1.0, v245
    v_add_f32 v246, 1.0, v246
    v_add_f32 v247, 1.0, v247
    v_rcp_f32 v240, v240
    v_rcp_f32 v241, v241
    s_waitcnt lgkmcnt(5)
    v_mfma_f32_32x32x16_bf16 v[64:79], v[104:107], v[96:99], v[64:79]
    s_waitcnt lgkmcnt(0)
    s_barrier
    ds_read_b128 v[128:131], v148 offset:32768
    ds_read_b64_tr_b16 v[136:137], v155 offset:16384
    v_rcp_f32 v242, v242
    v_rcp_f32 v243, v243
    v_rcp_f32 v244, v244
    v_rcp_f32 v245, v245
    v_rcp_f32 v246, v246
    v_rcp_f32 v247, v247
    v_mfma_f32_32x32x16_bf16 v[80:95], v[104:107], v[100:103], v[80:95]
    ds_read_b64_tr_b16 v[138:139], v155 offset:16896
    ds_read_b128 v[132:135], v148 offset:36864
    v_mul_f32 v240, v240, v40
    v_mul_f32 v241, v241, v41
    v_mul_f32 v242, v242, v42
    v_mul_f32 v243, v243, v43
    v_mul_f32 v244, v244, v44
    v_mul_f32 v245, v245, v45
    v_mfma_f32_32x32x16_bf16 v[64:79], v[120:123], v[112:115], v[64:79]
    ds_read_b128 v[96:99], v149 offset:32768
    ds_read_b64_tr_b16 v[104:105], v155 offset:18432
    v_mul_f32 v246, v246, v46
    v_mul_f32 v247, v247, v47
    v_cvt_pk_bf16_f32 v40, v240, v241
    v_cvt_pk_bf16_f32 v41, v242, v243
    v_cvt_pk_bf16_f32 v42, v244, v245
    v_cvt_pk_bf16_f32 v43, v246, v247
    v_mfma_f32_32x32x16_bf16 v[80:95], v[120:123], v[116:119], v[80:95]
    ds_read_b64_tr_b16 v[106:107], v155 offset:18944
    ds_read_b128 v[100:103], v149 offset:36864
    buffer_store_dwordx4 v[40:43], v234, s[20:23], s73 offen sc1
    v_mul_f32 v240, s70, v48
    v_mul_f32 v241, s70, v49
    v_mul_f32 v242, s70, v50
    v_mul_f32 v243, s70, v51
    v_mul_f32 v244, s70, v52
    s_waitcnt lgkmcnt(5)
    v_mfma_f32_32x32x16_bf16 v[64:79], v[136:139], v[128:131], v[64:79]
    ds_read_b128 v[112:115], v150 offset:32768
    ds_read_b64_tr_b16 v[120:121], v155 offset:20480
    v_mul_f32 v245, s70, v53
    v_mul_f32 v246, s70, v54
    v_mul_f32 v247, s70, v55
    v_exp_f32 v240, v240
    v_exp_f32 v241, v241
    v_exp_f32 v242, v242
    s_waitcnt lgkmcnt(6)
    v_mfma_f32_32x32x16_bf16 v[80:95], v[136:139], v[132:135], v[80:95]
    ds_read_b64_tr_b16 v[122:123], v155 offset:20992
    ds_read_b128 v[116:119], v150 offset:36864
    v_exp_f32 v243, v243
    v_exp_f32 v244, v244
    v_exp_f32 v245, v245
    v_exp_f32 v246, v246
    v_exp_f32 v247, v247
    v_add_f32 v240, 1.0, v240
    s_waitcnt lgkmcnt(5)
    v_mfma_f32_32x32x16_bf16 v[64:79], v[104:107], v[96:99], v[64:79]
    ds_read_b128 v[128:131], v151 offset:32768
    ds_read_b64_tr_b16 v[136:137], v155 offset:22528
    v_add_f32 v241, 1.0, v241
    v_add_f32 v242, 1.0, v242
    v_add_f32 v243, 1.0, v243
    v_add_f32 v244, 1.0, v244
    v_add_f32 v245, 1.0, v245
    v_add_f32 v246, 1.0, v246
    s_waitcnt lgkmcnt(6)
    v_mfma_f32_32x32x16_bf16 v[80:95], v[104:107], v[100:103], v[80:95]
    ds_read_b64_tr_b16 v[138:139], v155 offset:23040
    ds_read_b128 v[132:135], v151 offset:36864
    v_add_f32 v247, 1.0, v247
    v_rcp_f32 v240, v240
    v_rcp_f32 v241, v241
    v_rcp_f32 v242, v242
    v_rcp_f32 v243, v243
    v_rcp_f32 v244, v244
    s_waitcnt lgkmcnt(5)
    v_mfma_f32_32x32x16_bf16 v[64:79], v[120:123], v[112:115], v[64:79]
    ds_read_b128 v[96:99], v148 offset:49152
    ds_read_b64_tr_b16 v[104:105], v155 offset:24576
    v_rcp_f32 v245, v245
    v_rcp_f32 v246, v246
    v_rcp_f32 v247, v247
    v_mul_f32 v240, v240, v48
    v_mul_f32 v241, v241, v49
    v_mul_f32 v242, v242, v50
    s_waitcnt lgkmcnt(6)
    v_mfma_f32_32x32x16_bf16 v[80:95], v[120:123], v[116:119], v[80:95]
    ds_read_b64_tr_b16 v[106:107], v155 offset:25088
    ds_read_b128 v[100:103], v148 offset:53248
    v_mul_f32 v243, v243, v51
    v_mul_f32 v244, v244, v52
    v_mul_f32 v245, v245, v53
    v_mul_f32 v246, v246, v54
    v_mul_f32 v247, v247, v55
    v_cvt_pk_bf16_f32 v48, v240, v241
    s_waitcnt lgkmcnt(5)
    v_mfma_f32_32x32x16_bf16 v[64:79], v[136:139], v[128:131], v[64:79]
    ds_read_b128 v[112:115], v149 offset:49152
    ds_read_b64_tr_b16 v[120:121], v155 offset:26624
    v_cvt_pk_bf16_f32 v49, v242, v243
    v_cvt_pk_bf16_f32 v50, v244, v245
    v_cvt_pk_bf16_f32 v51, v246, v247
    buffer_store_dwordx4 v[48:51], v234, s[20:23], s74 offen sc1
    v_mul_f32 v240, s70, v56
    v_mul_f32 v241, s70, v57
    s_waitcnt lgkmcnt(6)
    v_mfma_f32_32x32x16_bf16 v[80:95], v[136:139], v[132:135], v[80:95]
    ds_read_b64_tr_b16 v[122:123], v155 offset:27136
    ds_read_b128 v[116:119], v149 offset:53248
    v_mul_f32 v242, s70, v58
    v_mul_f32 v243, s70, v59
    v_mul_f32 v244, s70, v60
    v_mul_f32 v245, s70, v61
    v_mul_f32 v246, s70, v62
    v_mul_f32 v247, s70, v63
    s_waitcnt lgkmcnt(5)
    v_mfma_f32_32x32x16_bf16 v[64:79], v[104:107], v[96:99], v[64:79]
    ds_read_b128 v[128:131], v150 offset:49152
    ds_read_b64_tr_b16 v[136:137], v155 offset:28672
    v_exp_f32 v240, v240
    v_exp_f32 v241, v241
    v_exp_f32 v242, v242
    v_exp_f32 v243, v243
    v_exp_f32 v244, v244
    v_exp_f32 v245, v245
    s_waitcnt lgkmcnt(6)
    v_mfma_f32_32x32x16_bf16 v[80:95], v[104:107], v[100:103], v[80:95]
    ds_read_b64_tr_b16 v[138:139], v155 offset:29184
    ds_read_b128 v[132:135], v150 offset:53248
    v_exp_f32 v246, v246
    v_exp_f32 v247, v247
    v_add_f32 v240, 1.0, v240
    v_add_f32 v241, 1.0, v241
    v_add_f32 v242, 1.0, v242
    v_add_f32 v243, 1.0, v243
    s_waitcnt lgkmcnt(5)
    v_mfma_f32_32x32x16_bf16 v[64:79], v[120:123], v[112:115], v[64:79]
    ds_read_b128 v[96:99], v151 offset:49152
    ds_read_b64_tr_b16 v[104:105], v155 offset:30720
    v_add_f32 v244, 1.0, v244
    v_add_f32 v245, 1.0, v245
    v_add_f32 v246, 1.0, v246
    v_add_f32 v247, 1.0, v247
    v_rcp_f32 v240, v240
    v_rcp_f32 v241, v241
    s_waitcnt lgkmcnt(6)
    v_mfma_f32_32x32x16_bf16 v[80:95], v[120:123], v[116:119], v[80:95]
    ds_read_b64_tr_b16 v[106:107], v155 offset:31232
    ds_read_b128 v[100:103], v151 offset:53248
    v_rcp_f32 v242, v242
    v_rcp_f32 v243, v243
    v_rcp_f32 v244, v244
    v_rcp_f32 v245, v245
    v_rcp_f32 v246, v246
    v_rcp_f32 v247, v247
    s_waitcnt lgkmcnt(5)
    v_mfma_f32_32x32x16_bf16 v[64:79], v[136:139], v[128:131], v[64:79]
    s_waitcnt lgkmcnt(0)
    s_barrier
    v_mul_f32 v240, v240, v56
    v_mul_f32 v241, v241, v57
    v_mul_f32 v242, v242, v58
    v_mul_f32 v243, v243, v59
    v_mul_f32 v244, v244, v60
    v_mul_f32 v245, v245, v61
    v_mfma_f32_32x32x16_bf16 v[80:95], v[136:139], v[132:135], v[80:95]
    v_mul_f32 v246, v246, v62
    v_mul_f32 v247, v247, v63
    v_cvt_pk_bf16_f32 v56, v240, v241
    v_cvt_pk_bf16_f32 v57, v242, v243
    v_cvt_pk_bf16_f32 v58, v244, v245
    v_cvt_pk_bf16_f32 v59, v246, v247
    v_mfma_f32_32x32x16_bf16 v[64:79], v[104:107], v[96:99], v[64:79]
    buffer_store_dwordx4 v[56:59], v234, s[20:23], s75 offen sc1
    s_waitcnt vmcnt(4)
    v_mov_b32 v253, 0
    v_mov_b32 v255, s62
    s_mov_b64 exec, 1
    buffer_store_dword v255, v253, s[20:23], s77 offen sc1
    s_mov_b64 exec, -1
    v_mfma_f32_32x32x16_bf16 v[80:95], v[104:107], v[100:103], v[80:95]
    s_waitcnt lgkmcnt(0)
    s_nop 11
    v_pk_mul_f32 v[240:241], v[64:65], s[70:71] op_sel_hi:[1,0]
    v_pk_mul_f32 v[242:243], v[66:67], s[70:71] op_sel_hi:[1,0]
    v_pk_mul_f32 v[244:245], v[68:69], s[70:71] op_sel_hi:[1,0]
    v_pk_mul_f32 v[246:247], v[70:71], s[70:71] op_sel_hi:[1,0]
    v_exp_f32 v240, v240
    v_exp_f32 v241, v241
    v_exp_f32 v242, v242
    v_exp_f32 v243, v243
    v_exp_f32 v244, v244
    v_exp_f32 v245, v245
    v_exp_f32 v246, v246
    v_exp_f32 v247, v247
    v_pk_add_f32 v[240:241], v[240:241], 1.0 op_sel_hi:[1,0]
    v_pk_add_f32 v[242:243], v[242:243], 1.0 op_sel_hi:[1,0]
    v_pk_add_f32 v[244:245], v[244:245], 1.0 op_sel_hi:[1,0]
    v_pk_add_f32 v[246:247], v[246:247], 1.0 op_sel_hi:[1,0]
    v_rcp_f32 v240, v240
    v_rcp_f32 v241, v241
    v_rcp_f32 v242, v242
    v_rcp_f32 v243, v243
    v_rcp_f32 v244, v244
    v_rcp_f32 v245, v245
    v_rcp_f32 v246, v246
    v_rcp_f32 v247, v247
    v_pk_mul_f32 v[240:241], v[240:241], v[64:65]
    v_pk_mul_f32 v[242:243], v[242:243], v[66:67]
    v_pk_mul_f32 v[244:245], v[244:245], v[68:69]
    v_pk_mul_f32 v[246:247], v[246:247], v[70:71]
    v_cvt_pk_bf16_f32 v64, v240, v241
    v_cvt_pk_bf16_f32 v65, v242, v243
    v_cvt_pk_bf16_f32 v66, v244, v245
    v_cvt_pk_bf16_f32 v67, v246, v247
    buffer_store_dwordx4 v[64:67], v235, s[20:23], s72 offen sc1
    v_pk_mul_f32 v[240:241], v[72:73], s[70:71] op_sel_hi:[1,0]
    v_pk_mul_f32 v[242:243], v[74:75], s[70:71] op_sel_hi:[1,0]
    v_pk_mul_f32 v[244:245], v[76:77], s[70:71] op_sel_hi:[1,0]
    v_pk_mul_f32 v[246:247], v[78:79], s[70:71] op_sel_hi:[1,0]
    v_exp_f32 v240, v240
    v_exp_f32 v241, v241
    v_exp_f32 v242, v242
    v_exp_f32 v243, v243
    v_exp_f32 v244, v244
    v_exp_f32 v245, v245
    v_exp_f32 v246, v246
    v_exp_f32 v247, v247
    v_pk_add_f32 v[240:241], v[240:241], 1.0 op_sel_hi:[1,0]
    v_pk_add_f32 v[242:243], v[242:243], 1.0 op_sel_hi:[1,0]
    v_pk_add_f32 v[244:245], v[244:245], 1.0 op_sel_hi:[1,0]
    v_pk_add_f32 v[246:247], v[246:247], 1.0 op_sel_hi:[1,0]
    v_rcp_f32 v240, v240
    v_rcp_f32 v241, v241
    v_rcp_f32 v242, v242
    v_rcp_f32 v243, v243
    v_rcp_f32 v244, v244
    v_rcp_f32 v245, v245
    v_rcp_f32 v246, v246
    v_rcp_f32 v247, v247
    v_pk_mul_f32 v[240:241], v[240:241], v[72:73]
    v_pk_mul_f32 v[242:243], v[242:243], v[74:75]
    v_pk_mul_f32 v[244:245], v[244:245], v[76:77]
    v_pk_mul_f32 v[246:247], v[246:247], v[78:79]
    v_cvt_pk_bf16_f32 v72, v240, v241
    v_cvt_pk_bf16_f32 v73, v242, v243
    v_cvt_pk_bf16_f32 v74, v244, v245
    v_cvt_pk_bf16_f32 v75, v246, v247
    buffer_store_dwordx4 v[72:75], v235, s[20:23], s73 offen sc1
    v_pk_mul_f32 v[240:241], v[80:81], s[70:71] op_sel_hi:[1,0]
    v_pk_mul_f32 v[242:243], v[82:83], s[70:71] op_sel_hi:[1,0]
    v_pk_mul_f32 v[244:245], v[84:85], s[70:71] op_sel_hi:[1,0]
    v_pk_mul_f32 v[246:247], v[86:87], s[70:71] op_sel_hi:[1,0]
    v_exp_f32 v240, v240
    v_exp_f32 v241, v241
    v_exp_f32 v242, v242
    v_exp_f32 v243, v243
    v_exp_f32 v244, v244
    v_exp_f32 v245, v245
    v_exp_f32 v246, v246
    v_exp_f32 v247, v247
    v_pk_add_f32 v[240:241], v[240:241], 1.0 op_sel_hi:[1,0]
    v_pk_add_f32 v[242:243], v[242:243], 1.0 op_sel_hi:[1,0]
    v_pk_add_f32 v[244:245], v[244:245], 1.0 op_sel_hi:[1,0]
    v_pk_add_f32 v[246:247], v[246:247], 1.0 op_sel_hi:[1,0]
    v_rcp_f32 v240, v240
    v_rcp_f32 v241, v241
    v_rcp_f32 v242, v242
    v_rcp_f32 v243, v243
    v_rcp_f32 v244, v244
    v_rcp_f32 v245, v245
    v_rcp_f32 v246, v246
    v_rcp_f32 v247, v247
    v_pk_mul_f32 v[240:241], v[240:241], v[80:81]
    v_pk_mul_f32 v[242:243], v[242:243], v[82:83]
    v_pk_mul_f32 v[244:245], v[244:245], v[84:85]
    v_pk_mul_f32 v[246:247], v[246:247], v[86:87]
    v_cvt_pk_bf16_f32 v80, v240, v241
    v_cvt_pk_bf16_f32 v81, v242, v243
    v_cvt_pk_bf16_f32 v82, v244, v245
    v_cvt_pk_bf16_f32 v83, v246, v247
    buffer_store_dwordx4 v[80:83], v235, s[20:23], s74 offen sc1
    v_pk_mul_f32 v[240:241], v[88:89], s[70:71] op_sel_hi:[1,0]
    v_pk_mul_f32 v[242:243], v[90:91], s[70:71] op_sel_hi:[1,0]
    v_pk_mul_f32 v[244:245], v[92:93], s[70:71] op_sel_hi:[1,0]
    v_pk_mul_f32 v[246:247], v[94:95], s[70:71] op_sel_hi:[1,0]
    v_exp_f32 v240, v240
    v_exp_f32 v241, v241
    v_exp_f32 v242, v242
    v_exp_f32 v243, v243
    v_exp_f32 v244, v244
    v_exp_f32 v245, v245
    v_exp_f32 v246, v246
    v_exp_f32 v247, v247
    v_pk_add_f32 v[240:241], v[240:241], 1.0 op_sel_hi:[1,0]
    v_pk_add_f32 v[242:243], v[242:243], 1.0 op_sel_hi:[1,0]
    v_pk_add_f32 v[244:245], v[244:245], 1.0 op_sel_hi:[1,0]
    v_pk_add_f32 v[246:247], v[246:247], 1.0 op_sel_hi:[1,0]
    v_rcp_f32 v240, v240
    v_rcp_f32 v241, v241
    v_rcp_f32 v242, v242
    v_rcp_f32 v243, v243
    v_rcp_f32 v244, v244
    v_rcp_f32 v245, v245
    v_rcp_f32 v246, v246
    v_rcp_f32 v247, v247
    v_pk_mul_f32 v[240:241], v[240:241], v[88:89]
    v_pk_mul_f32 v[242:243], v[242:243], v[90:91]
    v_pk_mul_f32 v[244:245], v[244:245], v[92:93]
    v_pk_mul_f32 v[246:247], v[246:247], v[94:95]
    v_cvt_pk_bf16_f32 v88, v240, v241
    v_cvt_pk_bf16_f32 v89, v242, v243
    v_cvt_pk_bf16_f32 v90, v244, v245
    v_cvt_pk_bf16_f32 v91, v246, v247
    buffer_store_dwordx4 v[88:91], v235, s[20:23], s75 offen sc1
    s_waitcnt vmcnt(5)
    s_add_u32 s77, s77, 0x4000
    v_mov_b32 v253, 0
    v_mov_b32 v255, s62
    s_mov_b64 exec, 1
    buffer_store_dword v255, v253, s[20:23], s77 offen sc1
    s_mov_b64 exec, -1
    s_barrier
    buffer_load_dword v250, v218, s[20:23], s46 offen sc1
    ds_read_b64_tr_b16 v[120:121], v216 offset:32768
    ds_read_b64_tr_b16 v[122:123], v216 offset:33792
    ds_read_b64_tr_b16 v[124:125], v217 offset:32768
    ds_read_b64_tr_b16 v[126:127], v217 offset:33792
    ds_read_b64_tr_b16 v[128:129], v216 offset:40960
    ds_read_b64_tr_b16 v[130:131], v216 offset:41984
    ds_read_b64_tr_b16 v[132:133], v217 offset:40960
    ds_read_b64_tr_b16 v[134:135], v217 offset:41984
    s_waitcnt lgkmcnt(8)
    ds_read_b64_tr_b16 v[144:145], v216 offset:49152
    ds_read_b64_tr_b16 v[146:147], v216 offset:50176
    ds_read_b64_tr_b16 v[148:149], v217 offset:49152
    ds_read_b64_tr_b16 v[150:151], v217 offset:50176
    s_waitcnt lgkmcnt(8)
    ds_read_b64_tr_b16 v[152:153], v216 offset:57344
    ds_read_b64_tr_b16 v[154:155], v216 offset:58368
    ds_read_b64_tr_b16 v[156:157], v217 offset:57344
    ds_read_b64_tr_b16 v[158:159], v217 offset:58368
    s_waitcnt lgkmcnt(8)
    v_add_u32 v216, 65536, v216
    v_add_u32 v217, 65536, v217
    ds_read_b64_tr_b16 v[168:169], v216 offset:0
    ds_read_b64_tr_b16 v[170:171], v216 offset:1024
    ds_read_b64_tr_b16 v[172:173], v217 offset:0
    ds_read_b64_tr_b16 v[174:175], v217 offset:1024
    s_waitcnt lgkmcnt(8)
    ds_read_b64_tr_b16 v[176:177], v216 offset:8192
    ds_read_b64_tr_b16 v[178:179], v216 offset:9216
    ds_read_b64_tr_b16 v[180:181], v217 offset:8192
    ds_read_b64_tr_b16 v[182:183], v217 offset:9216
    s_waitcnt lgkmcnt(8)
    ds_read_b64_tr_b16 v[192:193], v216 offset:16384
    ds_read_b64_tr_b16 v[194:195], v216 offset:17408
    ds_read_b64_tr_b16 v[196:197], v217 offset:16384
    ds_read_b64_tr_b16 v[198:199], v217 offset:17408
    s_waitcnt lgkmcnt(8)
    ds_read_b64_tr_b16 v[200:201], v216 offset:24576
    ds_read_b64_tr_b16 v[202:203], v216 offset:25600
    ds_read_b64_tr_b16 v[204:205], v217 offset:24576
    ds_read_b64_tr_b16 v[206:207], v217 offset:25600
    s_waitcnt lgkmcnt(8)
    v_add_u32 v216, 65536, v216
    v_add_u32 v217, 65536, v217
    ds_read_b64_tr_b16 v[184:185], v216 offset:0
    ds_read_b64_tr_b16 v[186:187], v216 offset:1024
    ds_read_b64_tr_b16 v[188:189], v217 offset:0
    ds_read_b64_tr_b16 v[190:191], v217 offset:1024
    s_waitcnt lgkmcnt(8)
    ds_read_b64_tr_b16 v[208:209], v216 offset:8192
    ds_read_b64_tr_b16 v[210:211], v216 offset:9216
    ds_read_b64_tr_b16 v[212:213], v217 offset:8192
    ds_read_b64_tr_b16 v[214:215], v217 offset:9216
    s_waitcnt lgkmcnt(8)
    ds_read_b64_tr_b16 v[136:137], v216 offset:16384
    ds_read_b64_tr_b16 v[138:139], v216 offset:17408
    ds_read_b64_tr_b16 v[140:141], v217 offset:16384
    ds_read_b64_tr_b16 v[142:143], v217 offset:17408
    s_waitcnt lgkmcnt(8)
    ds_read_b64_tr_b16 v[160:161], v216 offset:24576
    ds_read_b64_tr_b16 v[162:163], v216 offset:25600
    ds_read_b64_tr_b16 v[164:165], v217 offset:24576
    ds_read_b64_tr_b16 v[166:167], v217 offset:25600
    s_waitcnt lgkmcnt(8)
    s_waitcnt lgkmcnt(0)
    s_waitcnt vmcnt(2)
    s_add_u32 s77, s77, 0x4000
    v_mov_b32 v253, 0
    v_mov_b32 v255, s62
    s_mov_b64 exec, 1
    buffer_store_dword v255, v253, s[20:23], s77 offen sc1
    s_mov_b64 exec, -1
    s_barrier
    s_add_u32 m0, s0, 32768
    s_add_u32 s35, s1, 917504
    buffer_load_dwordx4 v236, s[12:15], s35 offen lds
    s_add_u32 m0, s0, 40960
    s_add_u32 s35, s1, 1114112
    buffer_load_dwordx4 v236, s[12:15], s35 offen lds
    s_add_u32 m0, s0, 147456
    s_add_u32 s35, s1, 1310720
    buffer_load_dwordx4 v236, s[12:15], s35 offen lds
    s_waitcnt vmcnt(4)
    s_branch L_phase2_f
L_f_gate:
    s_waitcnt lgkmcnt(0)
    s_barrier
    s_barrier
    s_barrier
    s_nop 7
    v_pk_mul_f32 v[240:241], v[0:1], s[70:71] op_sel_hi:[1,0]
    v_pk_mul_f32 v[242:243], v[2:3], s[70:71] op_sel_hi:[1,0]
    v_pk_mul_f32 v[244:245], v[4:5], s[70:71] op_sel_hi:[1,0]
    v_pk_mul_f32 v[246:247], v[6:7], s[70:71] op_sel_hi:[1,0]
    v_exp_f32 v240, v240
    v_exp_f32 v241, v241
    v_exp_f32 v242, v242
    v_exp_f32 v243, v243
    v_exp_f32 v244, v244
    v_exp_f32 v245, v245
    v_exp_f32 v246, v246
    v_exp_f32 v247, v247
    v_pk_add_f32 v[240:241], v[240:241], 1.0 op_sel_hi:[1,0]
    v_pk_add_f32 v[242:243], v[242:243], 1.0 op_sel_hi:[1,0]
    v_pk_add_f32 v[244:245], v[244:245], 1.0 op_sel_hi:[1,0]
    v_pk_add_f32 v[246:247], v[246:247], 1.0 op_sel_hi:[1,0]
    v_rcp_f32 v240, v240
    v_rcp_f32 v241, v241
    v_rcp_f32 v242, v242
    v_rcp_f32 v243, v243
    v_rcp_f32 v244, v244
    v_rcp_f32 v245, v245
    v_rcp_f32 v246, v246
    v_rcp_f32 v247, v247
    v_pk_mul_f32 v[240:241], v[240:241], v[0:1]
    v_pk_mul_f32 v[242:243], v[242:243], v[2:3]
    v_pk_mul_f32 v[244:245], v[244:245], v[4:5]
    v_pk_mul_f32 v[246:247], v[246:247], v[6:7]
    v_cvt_pk_bf16_f32 v0, v240, v241
    v_cvt_pk_bf16_f32 v1, v242, v243
    v_cvt_pk_bf16_f32 v2, v244, v245
    v_cvt_pk_bf16_f32 v3, v246, v247
    buffer_store_dwordx4 v[0:3], v233, s[20:23], s72 offen sc1
    v_pk_mul_f32 v[240:241], v[8:9], s[70:71] op_sel_hi:[1,0]
    v_pk_mul_f32 v[242:243], v[10:11], s[70:71] op_sel_hi:[1,0]
    v_pk_mul_f32 v[244:245], v[12:13], s[70:71] op_sel_hi:[1,0]
    v_pk_mul_f32 v[246:247], v[14:15], s[70:71] op_sel_hi:[1,0]
    v_exp_f32 v240, v240
    v_exp_f32 v241, v241
    v_exp_f32 v242, v242
    v_exp_f32 v243, v243
    v_exp_f32 v244, v244
    v_exp_f32 v245, v245
    v_exp_f32 v246, v246
    v_exp_f32 v247, v247
    v_pk_add_f32 v[240:241], v[240:241], 1.0 op_sel_hi:[1,0]
    v_pk_add_f32 v[242:243], v[242:243], 1.0 op_sel_hi:[1,0]
    v_pk_add_f32 v[244:245], v[244:245], 1.0 op_sel_hi:[1,0]
    v_pk_add_f32 v[246:247], v[246:247], 1.0 op_sel_hi:[1,0]
    v_rcp_f32 v240, v240
    v_rcp_f32 v241, v241
    v_rcp_f32 v242, v242
    v_rcp_f32 v243, v243
    v_rcp_f32 v244, v244
    v_rcp_f32 v245, v245
    v_rcp_f32 v246, v246
    v_rcp_f32 v247, v247
    v_pk_mul_f32 v[240:241], v[240:241], v[8:9]
    v_pk_mul_f32 v[242:243], v[242:243], v[10:11]
    v_pk_mul_f32 v[244:245], v[244:245], v[12:13]
    v_pk_mul_f32 v[246:247], v[246:247], v[14:15]
    v_cvt_pk_bf16_f32 v8, v240, v241
    v_cvt_pk_bf16_f32 v9, v242, v243
    v_cvt_pk_bf16_f32 v10, v244, v245
    v_cvt_pk_bf16_f32 v11, v246, v247
    buffer_store_dwordx4 v[8:11], v233, s[20:23], s73 offen sc1
    v_pk_mul_f32 v[240:241], v[16:17], s[70:71] op_sel_hi:[1,0]
    v_pk_mul_f32 v[242:243], v[18:19], s[70:71] op_sel_hi:[1,0]
    v_pk_mul_f32 v[244:245], v[20:21], s[70:71] op_sel_hi:[1,0]
    v_pk_mul_f32 v[246:247], v[22:23], s[70:71] op_sel_hi:[1,0]
    v_exp_f32 v240, v240
    v_exp_f32 v241, v241
    v_exp_f32 v242, v242
    v_exp_f32 v243, v243
    v_exp_f32 v244, v244
    v_exp_f32 v245, v245
    v_exp_f32 v246, v246
    v_exp_f32 v247, v247
    v_pk_add_f32 v[240:241], v[240:241], 1.0 op_sel_hi:[1,0]
    v_pk_add_f32 v[242:243], v[242:243], 1.0 op_sel_hi:[1,0]
    v_pk_add_f32 v[244:245], v[244:245], 1.0 op_sel_hi:[1,0]
    v_pk_add_f32 v[246:247], v[246:247], 1.0 op_sel_hi:[1,0]
    v_rcp_f32 v240, v240
    v_rcp_f32 v241, v241
    v_rcp_f32 v242, v242
    v_rcp_f32 v243, v243
    v_rcp_f32 v244, v244
    v_rcp_f32 v245, v245
    v_rcp_f32 v246, v246
    v_rcp_f32 v247, v247
    v_pk_mul_f32 v[240:241], v[240:241], v[16:17]
    v_pk_mul_f32 v[242:243], v[242:243], v[18:19]
    v_pk_mul_f32 v[244:245], v[244:245], v[20:21]
    v_pk_mul_f32 v[246:247], v[246:247], v[22:23]
    v_cvt_pk_bf16_f32 v16, v240, v241
    v_cvt_pk_bf16_f32 v17, v242, v243
    v_cvt_pk_bf16_f32 v18, v244, v245
    v_cvt_pk_bf16_f32 v19, v246, v247
    buffer_store_dwordx4 v[16:19], v233, s[20:23], s74 offen sc1
    v_pk_mul_f32 v[240:241], v[24:25], s[70:71] op_sel_hi:[1,0]
    v_pk_mul_f32 v[242:243], v[26:27], s[70:71] op_sel_hi:[1,0]
    v_pk_mul_f32 v[244:245], v[28:29], s[70:71] op_sel_hi:[1,0]
    v_pk_mul_f32 v[246:247], v[30:31], s[70:71] op_sel_hi:[1,0]
    v_exp_f32 v240, v240
    v_exp_f32 v241, v241
    v_exp_f32 v242, v242
    v_exp_f32 v243, v243
    v_exp_f32 v244, v244
    v_exp_f32 v245, v245
    v_exp_f32 v246, v246
    v_exp_f32 v247, v247
    v_pk_add_f32 v[240:241], v[240:241], 1.0 op_sel_hi:[1,0]
    v_pk_add_f32 v[242:243], v[242:243], 1.0 op_sel_hi:[1,0]
    v_pk_add_f32 v[244:245], v[244:245], 1.0 op_sel_hi:[1,0]
    v_pk_add_f32 v[246:247], v[246:247], 1.0 op_sel_hi:[1,0]
    v_rcp_f32 v240, v240
    v_rcp_f32 v241, v241
    v_rcp_f32 v242, v242
    v_rcp_f32 v243, v243
    v_rcp_f32 v244, v244
    v_rcp_f32 v245, v245
    v_rcp_f32 v246, v246
    v_rcp_f32 v247, v247
    v_pk_mul_f32 v[240:241], v[240:241], v[24:25]
    v_pk_mul_f32 v[242:243], v[242:243], v[26:27]
    v_pk_mul_f32 v[244:245], v[244:245], v[28:29]
    v_pk_mul_f32 v[246:247], v[246:247], v[30:31]
    v_cvt_pk_bf16_f32 v24, v240, v241
    v_cvt_pk_bf16_f32 v25, v242, v243
    v_cvt_pk_bf16_f32 v26, v244, v245
    v_cvt_pk_bf16_f32 v27, v246, v247
    buffer_store_dwordx4 v[24:27], v233, s[20:23], s75 offen sc1
    v_mul_f32 v240, s70, v32
    v_mul_f32 v241, s70, v48
    v_exp_f32 v240, v240
    v_exp_f32 v241, v241
    v_lshlrev_b32 v242, 2, v254
    v_add_f32 v240, 1.0, v240
    v_add_f32 v241, 1.0, v241
    v_rcp_f32 v240, v240
    v_rcp_f32 v241, v241
    s_mov_b32 exec_hi, 0
    buffer_store_dword v240, v242, s[20:23], s76 offen sc1
    buffer_store_dword v241, v242, s[20:23], s76 offen offset:256 sc1
    s_mov_b64 exec, -1
    s_barrier
    s_waitcnt vmcnt(0)
    v_mov_b32 v253, 0
    v_mov_b32 v255, s62
    s_mov_b64 exec, 1
    buffer_store_dword v255, v253, s[20:23], s77 offen sc1
    s_mov_b64 exec, -1
    s_barrier
    s_barrier
    s_barrier
    buffer_load_dword v250, v218, s[20:23], s46 offen sc1
    ds_read_b64_tr_b16 v[120:121], v216 offset:32768
    ds_read_b64_tr_b16 v[122:123], v216 offset:33792
    ds_read_b64_tr_b16 v[124:125], v217 offset:32768
    ds_read_b64_tr_b16 v[126:127], v217 offset:33792
    ds_read_b64_tr_b16 v[128:129], v216 offset:40960
    ds_read_b64_tr_b16 v[130:131], v216 offset:41984
    ds_read_b64_tr_b16 v[132:133], v217 offset:40960
    ds_read_b64_tr_b16 v[134:135], v217 offset:41984
    s_waitcnt lgkmcnt(8)
    ds_read_b64_tr_b16 v[144:145], v216 offset:49152
    ds_read_b64_tr_b16 v[146:147], v216 offset:50176
    ds_read_b64_tr_b16 v[148:149], v217 offset:49152
    ds_read_b64_tr_b16 v[150:151], v217 offset:50176
    s_waitcnt lgkmcnt(8)
    ds_read_b64_tr_b16 v[152:153], v216 offset:57344
    ds_read_b64_tr_b16 v[154:155], v216 offset:58368
    ds_read_b64_tr_b16 v[156:157], v217 offset:57344
    ds_read_b64_tr_b16 v[158:159], v217 offset:58368
    s_waitcnt lgkmcnt(8)
    v_add_u32 v216, 65536, v216
    v_add_u32 v217, 65536, v217
    ds_read_b64_tr_b16 v[168:169], v216 offset:0
    ds_read_b64_tr_b16 v[170:171], v216 offset:1024
    ds_read_b64_tr_b16 v[172:173], v217 offset:0
    ds_read_b64_tr_b16 v[174:175], v217 offset:1024
    s_waitcnt lgkmcnt(8)
    ds_read_b64_tr_b16 v[176:177], v216 offset:8192
    ds_read_b64_tr_b16 v[178:179], v216 offset:9216
    ds_read_b64_tr_b16 v[180:181], v217 offset:8192
    ds_read_b64_tr_b16 v[182:183], v217 offset:9216
    s_waitcnt lgkmcnt(8)
    ds_read_b64_tr_b16 v[192:193], v216 offset:16384
    ds_read_b64_tr_b16 v[194:195], v216 offset:17408
    ds_read_b64_tr_b16 v[196:197], v217 offset:16384
    ds_read_b64_tr_b16 v[198:199], v217 offset:17408
    s_waitcnt lgkmcnt(8)
    ds_read_b64_tr_b16 v[200:201], v216 offset:24576
    ds_read_b64_tr_b16 v[202:203], v216 offset:25600
    ds_read_b64_tr_b16 v[204:205], v217 offset:24576
    ds_read_b64_tr_b16 v[206:207], v217 offset:25600
    s_waitcnt lgkmcnt(8)
    v_add_u32 v216, 65536, v216
    v_add_u32 v217, 65536, v217
    ds_read_b64_tr_b16 v[184:185], v216 offset:0
    ds_read_b64_tr_b16 v[186:187], v216 offset:1024
    ds_read_b64_tr_b16 v[188:189], v217 offset:0
    ds_read_b64_tr_b16 v[190:191], v217 offset:1024
    s_waitcnt lgkmcnt(8)
    ds_read_b64_tr_b16 v[208:209], v216 offset:8192
    ds_read_b64_tr_b16 v[210:211], v216 offset:9216
    ds_read_b64_tr_b16 v[212:213], v217 offset:8192
    ds_read_b64_tr_b16 v[214:215], v217 offset:9216
    s_waitcnt lgkmcnt(8)
    ds_read_b64_tr_b16 v[136:137], v216 offset:16384
    ds_read_b64_tr_b16 v[138:139], v216 offset:17408
    ds_read_b64_tr_b16 v[140:141], v217 offset:16384
    ds_read_b64_tr_b16 v[142:143], v217 offset:17408
    s_waitcnt lgkmcnt(8)
    ds_read_b64_tr_b16 v[160:161], v216 offset:24576
    ds_read_b64_tr_b16 v[162:163], v216 offset:25600
    ds_read_b64_tr_b16 v[164:165], v217 offset:24576
    ds_read_b64_tr_b16 v[166:167], v217 offset:25600
    s_waitcnt lgkmcnt(8)
    s_waitcnt lgkmcnt(0)
    s_waitcnt vmcnt(0)
    s_barrier
    s_add_u32 m0, s0, 32768
    s_add_u32 s35, s1, 917504
    buffer_load_dwordx4 v236, s[12:15], s35 offen lds
    s_add_u32 m0, s0, 40960
    s_add_u32 s35, s1, 1114112
    buffer_load_dwordx4 v236, s[12:15], s35 offen lds
    s_add_u32 m0, s0, 147456
    s_add_u32 s35, s1, 1310720
    buffer_load_dwordx4 v236, s[12:15], s35 offen lds
L_phase2_f:
    v_mov_b32 v239, s62
    v_cmp_ne_u32 vcc, s62, v250
    s_and_b32 s35, vcc_lo, 0x7f
    s_cbranch_scc1 L_p2_spin0_f
L_p2_ok0_f:
    buffer_load_dwordx4 v[64:67], v226, s[20:23], s48 offen sc1
    buffer_load_dwordx4 v[68:71], v227, s[20:23], s48 offen sc1
    buffer_load_dword v250, v218, s[20:23], s52 offen sc1
    buffer_load_dwordx4 v[72:75], v228, s[20:23], s48 offen sc1
    buffer_load_dwordx4 v[76:79], v229, s[20:23], s48 offen sc1
    s_add_u32 m0, s0, 49152
    s_add_u32 s35, s1, 1376256
    buffer_load_dwordx4 v236, s[12:15], s35 offen lds
    s_cmp_eq_u32 s33, 0
    s_cbranch_scc1 L_p2_nof_f
    s_waitcnt vmcnt(6)
    v_mov_b32 v253, 0
    v_mov_b32 v255, s62
    s_mov_b64 exec, 1
    buffer_store_dword v255, v253, s[20:23], s33 offen sc1
    s_mov_b64 exec, -1
L_p2_nof_f:
    s_waitcnt vmcnt(8)
    s_waitcnt vmcnt(7)
    s_waitcnt vmcnt(6)
    s_waitcnt vmcnt(5)
    buffer_load_dwordx4 v[80:83], v230, s[20:23], s48 offen sc1
    v_mfma_f32_32x32x16_bf16 v[0:15], v[120:123], v[64:67], 0
    v_mfma_f32_32x32x16_bf16 v[16:31], v[124:127], v[64:67], 0
    s_waitcnt vmcnt(5)
    s_add_u32 m0, s0, 57344
    s_add_u32 s35, s1, 0
    buffer_load_dwordx4 v236, s[16:19], s35 offen lds
    v_mfma_f32_32x32x16_bf16 v[0:15], v[128:131], v[68:71], v[0:15]
    v_mfma_f32_32x32x16_bf16 v[16:31], v[132:135], v[68:71], v[16:31]
    s_waitcnt vmcnt(5)
    v_cmp_ne_u32 vcc, s62, v250
    s_and_b32 s35, vcc_lo, 127
    s_cbranch_scc1 L_p2_spin1_f
L_p2_ok1_f:
    buffer_load_dwordx4 v[84:87], v231, s[20:23], s48 offen sc1
    s_waitcnt vmcnt(5)
    s_add_u32 m0, s0, 155648
    s_add_u32 s35, s1, 65536
    buffer_load_dwordx4 v236, s[16:19], s35 offen lds
    v_mfma_f32_32x32x16_bf16 v[0:15], v[136:139], v[72:75], v[0:15]
    v_mfma_f32_32x32x16_bf16 v[16:31], v[140:143], v[72:75], v[16:31]
    v_and_b32 v120, 31, v254
    v_lshrrev_b32 v121, 5, v254
    v_and_b32 v122, 7, v254
    v_xor_b32 v121, v121, v122
    v_lshlrev_b32 v120, 8, v120
    s_waitcnt vmcnt(5)
    buffer_load_dwordx4 v[88:91], v232, s[20:23], s48 offen sc1
    v_mfma_f32_32x32x16_bf16 v[0:15], v[144:147], v[76:79], v[0:15]
    v_mfma_f32_32x32x16_bf16 v[16:31], v[148:151], v[76:79], v[16:31]
    v_lshl_add_u32 v120, v121, 4, v120
    s_mul_i32 s67, s51, 98304
    s_lshl_b32 s66, s50, 13
    s_add_u32 s66, s66, s67
    v_add_u32 v120, s66, v120
    s_waitcnt vmcnt(5)
    s_add_u32 m0, s0, 65536
    s_add_u32 s35, s1, 131072
    buffer_load_dwordx4 v236, s[16:19], s35 offen lds
    s_waitcnt vmcnt(5)
    s_add_u32 s48, s48, 8192
    buffer_load_dwordx4 v[92:95], v226, s[20:23], s48 offen sc1
    v_mfma_f32_32x32x16_bf16 v[0:15], v[152:155], v[80:83], v[0:15]
    v_mfma_f32_32x32x16_bf16 v[16:31], v[156:159], v[80:83], v[16:31]
    v_xor_b32 v121, 32, v120
    v_xor_b32 v122, 64, v120
    v_xor_b32 v123, 96, v120
    v_lshrrev_b32 v124, 3, v254
    v_and_b32 v125, 7, v254
    s_waitcnt vmcnt(5)
    s_add_u32 m0, s0, 73728
    s_add_u32 s35, s1, 262144
    buffer_load_dwordx4 v236, s[16:19], s35 offen lds
    s_waitcnt vmcnt(5)
    buffer_load_dwordx4 v[96:99], v227, s[20:23], s48 offen sc1
    v_mfma_f32_32x32x16_bf16 v[0:15], v[160:163], v[84:87], v[0:15]
    v_mfma_f32_32x32x16_bf16 v[16:31], v[164:167], v[84:87], v[16:31]
    v_lshlrev_b32 v126, 1, v125
    v_xor_b32 v126, v126, v124
    v_lshlrev_b32 v127, 8, v124
    v_lshl_add_u32 v126, v126, 4, v127
    s_lshl_b32 s66, s50, 11
    s_waitcnt vmcnt(5)
    s_add_u32 m0, s0, 131072
    s_add_u32 s35, s1, 327680
    buffer_load_dwordx4 v236, s[16:19], s35 offen lds
    s_waitcnt vmcnt(5)
    buffer_load_dword v251, v218, s[20:23], s53 offen sc1
    v_mfma_f32_32x32x16_bf16 v[0:15], v[168:171], v[88:91], v[0:15]
    v_mfma_f32_32x32x16_bf16 v[16:31], v[172:175], v[88:91], v[16:31]
    s_add_u32 s66, s66, s67
    v_add_u32 v126, s66, v126
    v_xor_b32 v127, 16, v126
    v_lshlrev_b32 v124, 10, v124
    v_lshl_add_u32 v124, v125, 4, v124
    s_waitcnt vmcnt(5)
    buffer_load_dwordx4 v[100:103], v228, s[20:23], s48 offen sc1
    s_waitcnt vmcnt(5)
    s_add_u32 m0, s0, 81920
    s_add_u32 s35, s1, 393216
    buffer_load_dwordx4 v236, s[16:19], s35 offen lds
    v_mfma_f32_32x32x16_bf16 v[0:15], v[176:179], v[92:95], v[0:15]
    v_mfma_f32_32x32x16_bf16 v[16:31], v[180:183], v[92:95], v[16:31]
    s_lshl_b32 s66, s60, 16
    s_lshl_b32 s67, s56, 13
    s_add_u32 s66, s66, s67
    s_add_u32 s66, s66, s1
    s_waitcnt vmcnt(5)
    buffer_load_dwordx4 v[64:67], v229, s[20:23], s48 offen sc1
    s_waitcnt vmcnt(5)
    s_add_u32 m0, s0, 90112
    s_add_u32 s35, s1, 458752
    buffer_load_dwordx4 v236, s[16:19], s35 offen lds
    v_mfma_f32_32x32x16_bf16 v[0:15], v[184:187], v[96:99], v[0:15]
    v_mfma_f32_32x32x16_bf16 v[16:31], v[188:191], v[96:99], v[16:31]
    s_waitcnt vmcnt(5)
    buffer_load_dwordx4 v[68:71], v230, s[20:23], s48 offen sc1
    s_waitcnt vmcnt(5)
    v_cmp_ne_u32 vcc, s62, v251
    s_and_b32 s35, vcc_lo, 255
    s_cbranch_scc1 L_p2_spin2_f
L_p2_ok2_f:
    buffer_load_dword v222, v222, s[20:23], s47 offen sc1
    s_waitcnt vmcnt(5)
    s_add_u32 m0, s0, 139264
    s_add_u32 s35, s1, 196608
    buffer_load_dwordx4 v236, s[16:19], s35 offen lds
    v_mfma_f32_32x32x16_bf16 v[0:15], v[192:195], v[100:103], v[0:15]
    v_mfma_f32_32x32x16_bf16 v[16:31], v[196:199], v[100:103], v[16:31]
    s_waitcnt vmcnt(5)
    buffer_load_dwordx4 v[72:75], v231, s[20:23], s48 offen sc1
    s_waitcnt vmcnt(5)
    buffer_load_dwordx4 v[76:79], v232, s[20:23], s48 offen sc1
    v_mfma_f32_32x32x16_bf16 v[0:15], v[200:203], v[64:67], v[0:15]
    v_mfma_f32_32x32x16_bf16 v[16:31], v[204:207], v[64:67], v[16:31]
    v_subrev_u32 v216, 65536, v216
    v_subrev_u32 v217, 65536, v217
    ds_read_b64_tr_b16 v[104:105], v216 offset:32768
    ds_read_b64_tr_b16 v[106:107], v216 offset:33792
    ds_read_b64_tr_b16 v[108:109], v217 offset:32768
    ds_read_b64_tr_b16 v[110:111], v217 offset:33792
    s_waitcnt vmcnt(5)
    s_add_u32 s48, s48, 8192
    buffer_load_dwordx4 v[80:83], v226, s[20:23], s48 offen sc1
    s_waitcnt vmcnt(5)
    buffer_load_dwordx4 v[84:87], v227, s[20:23], s48 offen sc1
    v_mfma_f32_32x32x16_bf16 v[0:15], v[208:211], v[68:71], v[0:15]
    v_mfma_f32_32x32x16_bf16 v[16:31], v[212:215], v[68:71], v[16:31]
    ds_read_b64_tr_b16 v[112:113], v216 offset:40960
    ds_read_b64_tr_b16 v[114:115], v216 offset:41984
    ds_read_b64_tr_b16 v[116:117], v217 offset:40960
    ds_read_b64_tr_b16 v[118:119], v217 offset:41984
    s_waitcnt vmcnt(5)
    buffer_load_dwordx4 v[88:91], v228, s[20:23], s48 offen sc1
    s_waitcnt vmcnt(5)
    ds_write_b32 v238, v239
    buffer_load_dwordx4 v[92:95], v229, s[20:23], s48 offen sc1
    s_waitcnt vmcnt(5)
    buffer_load_dwordx4 v[96:99], v230, s[20:23], s48 offen sc1
    s_waitcnt lgkmcnt(7)
    v_mfma_f32_32x32x16_bf16 v[0:15], v[104:107], v[72:75], v[0:15]
    s_waitcnt lgkmcnt(5)
    v_mfma_f32_32x32x16_bf16 v[16:31], v[108:111], v[72:75], v[16:31]
    v_subrev_u32 v216, 65536, v216
    v_subrev_u32 v217, 65536, v217
    ds_read_b64_tr_b16 v[104:105], v216 offset:16384
    ds_read_b64_tr_b16 v[106:107], v216 offset:17408
    ds_read_b64_tr_b16 v[108:109], v217 offset:16384
    ds_read_b64_tr_b16 v[110:111], v217 offset:17408
    s_waitcnt vmcnt(5)
    buffer_load_dword v252, v218, s[20:23], s49 offen sc1
    s_waitcnt lgkmcnt(7)
    v_mfma_f32_32x32x16_bf16 v[0:15], v[112:115], v[76:79], v[0:15]
    s_waitcnt lgkmcnt(5)
    v_mfma_f32_32x32x16_bf16 v[16:31], v[116:119], v[76:79], v[16:31]
    v_add_u32 v216, 65536, v216
    v_add_u32 v217, 65536, v217
    ds_read_b64_tr_b16 v[112:113], v216 offset:49152
    ds_read_b64_tr_b16 v[114:115], v216 offset:50176
    ds_read_b64_tr_b16 v[116:117], v217 offset:49152
    ds_read_b64_tr_b16 v[118:119], v217 offset:50176
    s_waitcnt vmcnt(5)
    buffer_load_dwordx4 v[100:103], v231, s[20:23], s48 offen sc1
    s_waitcnt lgkmcnt(6)
    v_mfma_f32_32x32x16_bf16 v[0:15], v[104:107], v[80:83], v[0:15]
    s_waitcnt lgkmcnt(4)
    v_mfma_f32_32x32x16_bf16 v[16:31], v[108:111], v[80:83], v[16:31]
    ds_read_b64_tr_b16 v[104:105], v216 offset:57344
    ds_read_b64_tr_b16 v[106:107], v216 offset:58368
    ds_read_b64_tr_b16 v[108:109], v217 offset:57344
    ds_read_b64_tr_b16 v[110:111], v217 offset:58368
    s_waitcnt vmcnt(5)
    buffer_load_dwordx4 v[64:67], v232, s[20:23], s48 offen sc1
    s_waitcnt lgkmcnt(6)
    v_mfma_f32_32x32x16_bf16 v[0:15], v[112:115], v[84:87], v[0:15]
    s_waitcnt lgkmcnt(4)
    v_mfma_f32_32x32x16_bf16 v[16:31], v[116:119], v[84:87], v[16:31]
    v_subrev_u32 v216, 65536, v216
    v_subrev_u32 v217, 65536, v217
    ds_read_b64_tr_b16 v[112:113], v216 offset:24576
    ds_read_b64_tr_b16 v[114:115], v216 offset:25600
    ds_read_b64_tr_b16 v[116:117], v217 offset:24576
    ds_read_b64_tr_b16 v[118:119], v217 offset:25600
    s_waitcnt vmcnt(5)
    s_add_u32 s48, s48, 8192
    buffer_load_dwordx4 v[68:71], v226, s[20:23], s48 offen sc1
    s_waitcnt lgkmcnt(6)
    v_mfma_f32_32x32x16_bf16 v[0:15], v[104:107], v[88:91], v[0:15]
    s_waitcnt lgkmcnt(4)
    v_mfma_f32_32x32x16_bf16 v[16:31], v[108:111], v[88:91], v[16:31]
    ds_read_b32 v253, v219
    s_waitcnt vmcnt(5)
    s_waitcnt lgkmcnt(3)
    v_mfma_f32_32x32x16_bf16 v[0:15], v[112:115], v[92:95], v[0:15]
    s_waitcnt lgkmcnt(1)
    v_mfma_f32_32x32x16_bf16 v[16:31], v[116:119], v[92:95], v[16:31]
    s_waitcnt lgkmcnt(0)
    v_cmp_ne_u32 vcc, s62, v253
    s_cbranch_vccnz L_p2_lspin_f
L_p2_lok_f:
    ds_read_b64_tr_b16 v[104:105], v216 offset:32768
    ds_read_b64_tr_b16 v[106:107], v216 offset:33792
    ds_read_b64_tr_b16 v[108:109], v217 offset:32768
    ds_read_b64_tr_b16 v[110:111], v217 offset:33792
    ds_read_b64_tr_b16 v[112:113], v216 offset:40960
    ds_read_b64_tr_b16 v[114:115], v216 offset:41984
    ds_read_b64_tr_b16 v[116:117], v217 offset:40960
    ds_read_b64_tr_b16 v[118:119], v217 offset:41984
    s_waitcnt vmcnt(4)
    s_waitcnt lgkmcnt(6)
    v_mfma_f32_32x32x16_bf16 v[0:15], v[104:107], v[96:99], v[0:15]
    s_waitcnt lgkmcnt(4)
    v_mfma_f32_32x32x16_bf16 v[16:31], v[108:111], v[96:99], v[16:31]
    s_waitcnt vmcnt(3)
    v_cmp_ne_u32 vcc, s62, v252
    s_and_b32 s35, vcc_lo, 247
    s_cbranch_scc1 L_p2_spin3_f
L_p2_ok3_f:
    buffer_load_dwordx4 v[72:75], v227, s[20:23], s48 offen sc1
    buffer_load_dword v250, v218, s[20:23], s49 offen sc1
    buffer_load_dwordx4 v[76:79], v228, s[20:23], s48 offen sc1
    v_add_u32 v216, 131072, v216
    v_add_u32 v217, 131072, v217
    ds_read_b64_tr_b16 v[104:105], v216 offset:16384
    ds_read_b64_tr_b16 v[106:107], v216 offset:17408
    ds_read_b64_tr_b16 v[108:109], v217 offset:16384
    ds_read_b64_tr_b16 v[110:111], v217 offset:17408
    s_waitcnt vmcnt(5)
    buffer_load_dwordx4 v[80:83], v229, s[20:23], s48 offen sc1
    s_waitcnt lgkmcnt(6)
    v_mfma_f32_32x32x16_bf16 v[0:15], v[112:115], v[100:103], v[0:15]
    s_waitcnt lgkmcnt(4)
    v_mfma_f32_32x32x16_bf16 v[16:31], v[116:119], v[100:103], v[16:31]
    v_subrev_u32 v216, 131072, v216
    v_subrev_u32 v217, 131072, v217
    ds_read_b64_tr_b16 v[112:113], v216 offset:49152
    ds_read_b64_tr_b16 v[114:115], v216 offset:50176
    ds_read_b64_tr_b16 v[116:117], v217 offset:49152
    ds_read_b64_tr_b16 v[118:119], v217 offset:50176
    s_waitcnt vmcnt(5)
    buffer_load_dwordx4 v[84:87], v230, s[20:23], s48 offen sc1
    s_waitcnt lgkmcnt(6)
    v_mfma_f32_32x32x16_bf16 v[0:15], v[104:107], v[64:67], v[0:15]
    s_waitcnt lgkmcnt(4)
    v_mfma_f32_32x32x16_bf16 v[16:31], v[108:111], v[64:67], v[16:31]
    s_barrier
    ds_read_b64_tr_b16 v[104:105], v216 offset:57344
    ds_read_b64_tr_b16 v[106:107], v216 offset:58368
    ds_read_b64_tr_b16 v[108:109], v217 offset:57344
    ds_read_b64_tr_b16 v[110:111], v217 offset:58368
    s_waitcnt vmcnt(5)
    buffer_load_dwordx4 v[88:91], v231, s[20:23], s48 offen sc1
    s_waitcnt lgkmcnt(6)
    v_mfma_f32_32x32x16_bf16 v[0:15], v[112:115], v[68:71], v[0:15]
    s_waitcnt lgkmcnt(4)
    v_mfma_f32_32x32x16_bf16 v[16:31], v[116:119], v[68:71], v[16:31]
    v_add_u32 v216, 131072, v216
    v_add_u32 v217, 131072, v217
    ds_read_b64_tr_b16 v[112:113], v216 offset:24576
    ds_read_b64_tr_b16 v[114:115], v216 offset:25600
    ds_read_b64_tr_b16 v[116:117], v217 offset:24576
    ds_read_b64_tr_b16 v[118:119], v217 offset:25600
    s_waitcnt vmcnt(5)
    buffer_load_dwordx4 v[92:95], v232, s[20:23], s48 offen sc1
    s_waitcnt lgkmcnt(6)
    v_mfma_f32_32x32x16_bf16 v[32:47], v[104:107], v[72:75], 0
    s_waitcnt lgkmcnt(4)
    v_mfma_f32_32x32x16_bf16 v[48:63], v[108:111], v[72:75], 0
    s_waitcnt vmcnt(5)
    v_cmp_ne_u32 vcc, s62, v250
    s_and_b32 s35, vcc_lo, 8
    s_cbranch_scc1 L_p2_spin4_f
L_p2_ok4_f:
    s_add_u32 s48, s48, 8192
    buffer_load_dwordx4 v[96:99], v226, s[20:23], s48 offen sc1
    v_subrev_u32 v216, 65536, v216
    v_subrev_u32 v217, 65536, v217
    ds_read_b64_tr_b16 v[104:105], v216 offset:0
    ds_read_b64_tr_b16 v[106:107], v216 offset:1024
    ds_read_b64_tr_b16 v[108:109], v217 offset:0
    ds_read_b64_tr_b16 v[110:111], v217 offset:1024
    s_waitcnt vmcnt(5)
    buffer_load_dwordx4 v[100:103], v227, s[20:23], s48 offen sc1
    s_waitcnt lgkmcnt(6)
    v_mfma_f32_32x32x16_bf16 v[32:47], v[112:115], v[76:79], v[32:47]
    s_waitcnt lgkmcnt(4)
    v_mfma_f32_32x32x16_bf16 v[48:63], v[116:119], v[76:79], v[48:63]
    v_sub_f32 v224, 1.0, v222
    v_mul_f32 v0, v224, v0
    v_mul_f32 v1, v224, v1
    v_mul_f32 v2, v224, v2
    v_mul_f32 v3, v224, v3
    v_mul_f32 v4, v224, v4
    ds_read_b64_tr_b16 v[112:113], v216 offset:8192
    ds_read_b64_tr_b16 v[114:115], v216 offset:9216
    ds_read_b64_tr_b16 v[116:117], v217 offset:8192
    ds_read_b64_tr_b16 v[118:119], v217 offset:9216
    s_waitcnt vmcnt(5)
    s_waitcnt lgkmcnt(6)
    v_mfma_f32_32x32x16_bf16 v[32:47], v[104:107], v[80:83], v[32:47]
    s_waitcnt lgkmcnt(4)
    v_mfma_f32_32x32x16_bf16 v[48:63], v[108:111], v[80:83], v[48:63]
    v_mul_f32 v5, v224, v5
    v_mul_f32 v6, v224, v6
    v_mul_f32 v7, v224, v7
    v_mul_f32 v8, v224, v8
    v_mul_f32 v9, v224, v9
    v_mul_f32 v10, v224, v10
    v_add_u32 v216, 65536, v216
    v_add_u32 v217, 65536, v217
    ds_read_b64_tr_b16 v[104:105], v216 offset:0
    ds_read_b64_tr_b16 v[106:107], v216 offset:1024
    ds_read_b64_tr_b16 v[108:109], v217 offset:0
    ds_read_b64_tr_b16 v[110:111], v217 offset:1024
    s_waitcnt vmcnt(4)
    s_waitcnt lgkmcnt(6)
    v_mfma_f32_32x32x16_bf16 v[32:47], v[112:115], v[84:87], v[32:47]
    s_waitcnt lgkmcnt(4)
    v_mfma_f32_32x32x16_bf16 v[48:63], v[116:119], v[84:87], v[48:63]
    v_mul_f32 v11, v224, v11
    v_mul_f32 v12, v224, v12
    v_mul_f32 v13, v224, v13
    v_mul_f32 v14, v224, v14
    v_mul_f32 v15, v224, v15
    v_mul_f32 v16, v224, v16
    v_subrev_u32 v216, 65536, v216
    v_subrev_u32 v217, 65536, v217
    ds_read_b64_tr_b16 v[112:113], v216 offset:16384
    ds_read_b64_tr_b16 v[114:115], v216 offset:17408
    ds_read_b64_tr_b16 v[116:117], v217 offset:16384
    ds_read_b64_tr_b16 v[118:119], v217 offset:17408
    s_waitcnt vmcnt(3)
    s_waitcnt lgkmcnt(6)
    v_mfma_f32_32x32x16_bf16 v[32:47], v[104:107], v[88:91], v[32:47]
    s_waitcnt lgkmcnt(4)
    v_mfma_f32_32x32x16_bf16 v[48:63], v[108:111], v[88:91], v[48:63]
    v_mul_f32 v17, v224, v17
    v_mul_f32 v18, v224, v18
    v_mul_f32 v19, v224, v19
    v_mul_f32 v20, v224, v20
    v_mul_f32 v21, v224, v21
    v_mul_f32 v22, v224, v22
    ds_read_b64_tr_b16 v[104:105], v216 offset:24576
    ds_read_b64_tr_b16 v[106:107], v216 offset:25600
    ds_read_b64_tr_b16 v[108:109], v217 offset:24576
    ds_read_b64_tr_b16 v[110:111], v217 offset:25600
    s_waitcnt vmcnt(2)
    s_waitcnt lgkmcnt(6)
    v_mfma_f32_32x32x16_bf16 v[32:47], v[112:115], v[92:95], v[32:47]
    s_waitcnt lgkmcnt(4)
    v_mfma_f32_32x32x16_bf16 v[48:63], v[116:119], v[92:95], v[48:63]
    v_mul_f32 v23, v224, v23
    v_mul_f32 v24, v224, v24
    v_mul_f32 v25, v224, v25
    v_mul_f32 v26, v224, v26
    v_mul_f32 v27, v224, v27
    v_mul_f32 v28, v224, v28
    v_add_u32 v216, 65536, v216
    v_add_u32 v217, 65536, v217
    ds_read_b64_tr_b16 v[112:113], v216 offset:8192
    ds_read_b64_tr_b16 v[114:115], v216 offset:9216
    ds_read_b64_tr_b16 v[116:117], v217 offset:8192
    ds_read_b64_tr_b16 v[118:119], v217 offset:9216
    s_waitcnt vmcnt(1)
    s_waitcnt lgkmcnt(6)
    v_mfma_f32_32x32x16_bf16 v[32:47], v[104:107], v[96:99], v[32:47]
    s_waitcnt lgkmcnt(4)
    v_mfma_f32_32x32x16_bf16 v[48:63], v[108:111], v[96:99], v[48:63]
    v_mul_f32 v29, v224, v29
    v_mul_f32 v30, v224, v30
    v_mul_f32 v31, v224, v31
    s_waitcnt vmcnt(0)
    s_waitcnt lgkmcnt(2)
    v_mfma_f32_32x32x16_bf16 v[32:47], v[112:115], v[100:103], v[32:47]
    s_waitcnt lgkmcnt(0)
    v_mfma_f32_32x32x16_bf16 v[48:63], v[116:119], v[100:103], v[48:63]
    s_branch L_final
L_phase2_a:
    v_mov_b32 v239, s62
    v_cmp_ne_u32 vcc, s62, v250
    s_and_b32 s35, vcc_lo, 0x7f
    s_cbranch_scc1 L_p2_spin0_a
L_p2_ok0_a:
    buffer_load_dwordx4 v[64:67], v226, s[20:23], s48 offen sc1
    buffer_load_dwordx4 v[68:71], v227, s[20:23], s48 offen sc1
    buffer_load_dword v250, v218, s[20:23], s52 offen sc1
    buffer_load_dwordx4 v[72:75], v228, s[20:23], s48 offen sc1
    buffer_load_dwordx4 v[76:79], v229, s[20:23], s48 offen sc1
    buffer_load_dwordx4 v[80:83], v230, s[20:23], s48 offen sc1
    s_cmp_eq_u32 s33, 0
    s_cbranch_scc1 L_p2_nof_a
    s_waitcnt vmcnt(6)
    v_mov_b32 v253, 0
    v_mov_b32 v255, s62
    s_mov_b64 exec, 1
    buffer_store_dword v255, v253, s[20:23], s33 offen sc1
    s_mov_b64 exec, -1
L_p2_nof_a:
    s_waitcnt vmcnt(17)
    s_waitcnt vmcnt(16)
    s_waitcnt vmcnt(15)
    s_waitcnt vmcnt(14)
    s_waitcnt vmcnt(13)
    s_waitcnt vmcnt(12)
    s_waitcnt vmcnt(11)
    s_waitcnt vmcnt(10)
    s_waitcnt vmcnt(9)
    s_waitcnt vmcnt(8)
    s_waitcnt vmcnt(7)
    s_waitcnt vmcnt(6)
    ds_write_b32 v238, v239
    s_waitcnt vmcnt(5)
    buffer_load_dwordx4 v[84:87], v231, s[20:23], s48 offen sc1
    v_mfma_f32_32x32x16_bf16 v[0:15], v[120:123], v[64:67], 0
    v_mfma_f32_32x32x16_bf16 v[16:31], v[124:127], v[64:67], 0
    s_waitcnt vmcnt(5)
    buffer_load_dwordx4 v[88:91], v232, s[20:23], s48 offen sc1
    v_mfma_f32_32x32x16_bf16 v[0:15], v[128:131], v[68:71], v[0:15]
    v_mfma_f32_32x32x16_bf16 v[16:31], v[132:135], v[68:71], v[16:31]
    s_waitcnt vmcnt(5)
    v_cmp_ne_u32 vcc, s62, v250
    s_and_b32 s35, vcc_lo, 127
    s_cbranch_scc1 L_p2_spin1_a
L_p2_ok1_a:
    s_add_u32 s48, s48, 8192
    buffer_load_dwordx4 v[92:95], v226, s[20:23], s48 offen sc1
    s_waitcnt vmcnt(5)
    buffer_load_dwordx4 v[96:99], v227, s[20:23], s48 offen sc1
    v_mfma_f32_32x32x16_bf16 v[0:15], v[136:139], v[72:75], v[0:15]
    v_mfma_f32_32x32x16_bf16 v[16:31], v[140:143], v[72:75], v[16:31]
    v_and_b32 v120, 31, v254
    v_lshrrev_b32 v121, 5, v254
    v_and_b32 v122, 7, v254
    v_xor_b32 v121, v121, v122
    v_lshlrev_b32 v120, 8, v120
    s_waitcnt vmcnt(5)
    buffer_load_dword v251, v218, s[20:23], s53 offen sc1
    v_mfma_f32_32x32x16_bf16 v[0:15], v[144:147], v[76:79], v[0:15]
    v_mfma_f32_32x32x16_bf16 v[16:31], v[148:151], v[76:79], v[16:31]
    v_lshl_add_u32 v120, v121, 4, v120
    s_mul_i32 s67, s51, 98304
    s_lshl_b32 s66, s50, 13
    s_add_u32 s66, s66, s67
    v_add_u32 v120, s66, v120
    s_waitcnt vmcnt(5)
    buffer_load_dwordx4 v[100:103], v228, s[20:23], s48 offen sc1
    v_mfma_f32_32x32x16_bf16 v[0:15], v[152:155], v[80:83], v[0:15]
    v_mfma_f32_32x32x16_bf16 v[16:31], v[156:159], v[80:83], v[16:31]
    v_xor_b32 v121, 32, v120
    v_xor_b32 v122, 64, v120
    v_xor_b32 v123, 96, v120
    v_lshrrev_b32 v124, 3, v254
    v_and_b32 v125, 7, v254
    s_waitcnt vmcnt(5)
    buffer_load_dwordx4 v[64:67], v229, s[20:23], s48 offen sc1
    v_mfma_f32_32x32x16_bf16 v[0:15], v[160:163], v[84:87], v[0:15]
    v_mfma_f32_32x32x16_bf16 v[16:31], v[164:167], v[84:87], v[16:31]
    v_lshlrev_b32 v126, 1, v125
    v_xor_b32 v126, v126, v124
    v_lshlrev_b32 v127, 8, v124
    v_lshl_add_u32 v126, v126, 4, v127
    s_lshl_b32 s66, s50, 11
    s_waitcnt vmcnt(5)
    buffer_load_dwordx4 v[68:71], v230, s[20:23], s48 offen sc1
    v_mfma_f32_32x32x16_bf16 v[0:15], v[168:171], v[88:91], v[0:15]
    v_mfma_f32_32x32x16_bf16 v[16:31], v[172:175], v[88:91], v[16:31]
    s_add_u32 s66, s66, s67
    v_add_u32 v126, s66, v126
    v_xor_b32 v127, 16, v126
    v_lshlrev_b32 v124, 10, v124
    v_lshl_add_u32 v124, v125, 4, v124
    s_waitcnt vmcnt(5)
    buffer_load_dwordx4 v[72:75], v231, s[20:23], s48 offen sc1
    v_mfma_f32_32x32x16_bf16 v[0:15], v[176:179], v[92:95], v[0:15]
    v_mfma_f32_32x32x16_bf16 v[16:31], v[180:183], v[92:95], v[16:31]
    s_lshl_b32 s66, s60, 16
    s_lshl_b32 s67, s56, 13
    s_add_u32 s66, s66, s67
    s_add_u32 s66, s66, s1
    s_waitcnt vmcnt(5)
    buffer_load_dwordx4 v[76:79], v232, s[20:23], s48 offen sc1
    v_mfma_f32_32x32x16_bf16 v[0:15], v[184:187], v[96:99], v[0:15]
    v_mfma_f32_32x32x16_bf16 v[16:31], v[188:191], v[96:99], v[16:31]
    s_waitcnt vmcnt(5)
    v_cmp_ne_u32 vcc, s62, v251
    s_and_b32 s35, vcc_lo, 255
    s_cbranch_scc1 L_p2_spin2_a
L_p2_ok2_a:
    buffer_load_dword v222, v222, s[20:23], s47 offen sc1
    s_waitcnt vmcnt(5)
    s_add_u32 s48, s48, 8192
    buffer_load_dwordx4 v[80:83], v226, s[20:23], s48 offen sc1
    v_mfma_f32_32x32x16_bf16 v[0:15], v[192:195], v[100:103], v[0:15]
    v_mfma_f32_32x32x16_bf16 v[16:31], v[196:199], v[100:103], v[16:31]
    s_waitcnt vmcnt(5)
    buffer_load_dwordx4 v[84:87], v227, s[20:23], s48 offen sc1
    v_mfma_f32_32x32x16_bf16 v[0:15], v[200:203], v[64:67], v[0:15]
    v_mfma_f32_32x32x16_bf16 v[16:31], v[204:207], v[64:67], v[16:31]
    v_subrev_u32 v216, 65536, v216
    v_subrev_u32 v217, 65536, v217
    ds_read_b64_tr_b16 v[104:105], v216 offset:32768
    ds_read_b64_tr_b16 v[106:107], v216 offset:33792
    ds_read_b64_tr_b16 v[108:109], v217 offset:32768
    ds_read_b64_tr_b16 v[110:111], v217 offset:33792
    s_waitcnt vmcnt(5)
    buffer_load_dwordx4 v[88:91], v228, s[20:23], s48 offen sc1
    v_mfma_f32_32x32x16_bf16 v[0:15], v[208:211], v[68:71], v[0:15]
    v_mfma_f32_32x32x16_bf16 v[16:31], v[212:215], v[68:71], v[16:31]
    ds_read_b64_tr_b16 v[112:113], v216 offset:40960
    ds_read_b64_tr_b16 v[114:115], v216 offset:41984
    ds_read_b64_tr_b16 v[116:117], v217 offset:40960
    ds_read_b64_tr_b16 v[118:119], v217 offset:41984
    s_waitcnt vmcnt(5)
    buffer_load_dwordx4 v[92:95], v229, s[20:23], s48 offen sc1
    s_waitcnt lgkmcnt(6)
    v_mfma_f32_32x32x16_bf16 v[0:15], v[104:107], v[72:75], v[0:15]
    s_waitcnt lgkmcnt(4)
    v_mfma_f32_32x32x16_bf16 v[16:31], v[108:111], v[72:75], v[16:31]
    v_subrev_u32 v216, 65536, v216
    v_subrev_u32 v217, 65536, v217
    ds_read_b64_tr_b16 v[104:105], v216 offset:16384
    ds_read_b64_tr_b16 v[106:107], v216 offset:17408
    ds_read_b64_tr_b16 v[108:109], v217 offset:16384
    ds_read_b64_tr_b16 v[110:111], v217 offset:17408
    s_waitcnt vmcnt(5)
    buffer_load_dwordx4 v[96:99], v230, s[20:23], s48 offen sc1
    s_waitcnt lgkmcnt(6)
    v_mfma_f32_32x32x16_bf16 v[0:15], v[112:115], v[76:79], v[0:15]
    s_waitcnt lgkmcnt(4)
    v_mfma_f32_32x32x16_bf16 v[16:31], v[116:119], v[76:79], v[16:31]
    v_add_u32 v216, 65536, v216
    v_add_u32 v217, 65536, v217
    ds_read_b64_tr_b16 v[112:113], v216 offset:49152
    ds_read_b64_tr_b16 v[114:115], v216 offset:50176
    ds_read_b64_tr_b16 v[116:117], v217 offset:49152
    ds_read_b64_tr_b16 v[118:119], v217 offset:50176
    s_waitcnt vmcnt(5)
    buffer_load_dword v252, v218, s[20:23], s49 offen sc1
    s_waitcnt vmcnt(5)
    buffer_load_dwordx4 v[100:103], v231, s[20:23], s48 offen sc1
    s_waitcnt lgkmcnt(6)
    v_mfma_f32_32x32x16_bf16 v[0:15], v[104:107], v[80:83], v[0:15]
    s_waitcnt lgkmcnt(4)
    v_mfma_f32_32x32x16_bf16 v[16:31], v[108:111], v[80:83], v[16:31]
    ds_read_b64_tr_b16 v[104:105], v216 offset:57344
    ds_read_b64_tr_b16 v[106:107], v216 offset:58368
    ds_read_b64_tr_b16 v[108:109], v217 offset:57344
    ds_read_b64_tr_b16 v[110:111], v217 offset:58368
    s_waitcnt vmcnt(5)
    buffer_load_dwordx4 v[64:67], v232, s[20:23], s48 offen sc1
    s_waitcnt lgkmcnt(6)
    v_mfma_f32_32x32x16_bf16 v[0:15], v[112:115], v[84:87], v[0:15]
    s_waitcnt lgkmcnt(4)
    v_mfma_f32_32x32x16_bf16 v[16:31], v[116:119], v[84:87], v[16:31]
    v_subrev_u32 v216, 65536, v216
    v_subrev_u32 v217, 65536, v217
    ds_read_b64_tr_b16 v[112:113], v216 offset:24576
    ds_read_b64_tr_b16 v[114:115], v216 offset:25600
    ds_read_b64_tr_b16 v[116:117], v217 offset:24576
    ds_read_b64_tr_b16 v[118:119], v217 offset:25600
    s_waitcnt vmcnt(5)
    s_add_u32 s48, s48, 8192
    buffer_load_dwordx4 v[68:71], v226, s[20:23], s48 offen sc1
    s_waitcnt lgkmcnt(6)
    v_mfma_f32_32x32x16_bf16 v[0:15], v[104:107], v[88:91], v[0:15]
    s_waitcnt lgkmcnt(4)
    v_mfma_f32_32x32x16_bf16 v[16:31], v[108:111], v[88:91], v[16:31]
    ds_read_b32 v253, v219
    s_waitcnt vmcnt(5)
    s_waitcnt lgkmcnt(3)
    v_mfma_f32_32x32x16_bf16 v[0:15], v[112:115], v[92:95], v[0:15]
    s_waitcnt lgkmcnt(1)
    v_mfma_f32_32x32x16_bf16 v[16:31], v[116:119], v[92:95], v[16:31]
    s_waitcnt lgkmcnt(0)
    v_cmp_ne_u32 vcc, s62, v253
    s_cbranch_vccnz L_p2_lspin_a
L_p2_lok_a:
    ds_read_b64_tr_b16 v[104:105], v216 offset:32768
    ds_read_b64_tr_b16 v[106:107], v216 offset:33792
    ds_read_b64_tr_b16 v[108:109], v217 offset:32768
    ds_read_b64_tr_b16 v[110:111], v217 offset:33792
    ds_read_b64_tr_b16 v[112:113], v216 offset:40960
    ds_read_b64_tr_b16 v[114:115], v216 offset:41984
    ds_read_b64_tr_b16 v[116:117], v217 offset:40960
    ds_read_b64_tr_b16 v[118:119], v217 offset:41984
    s_waitcnt vmcnt(4)
    s_waitcnt lgkmcnt(6)
    v_mfma_f32_32x32x16_bf16 v[0:15], v[104:107], v[96:99], v[0:15]
    s_waitcnt lgkmcnt(4)
    v_mfma_f32_32x32x16_bf16 v[16:31], v[108:111], v[96:99], v[16:31]
    s_waitcnt vmcnt(3)
    v_cmp_ne_u32 vcc, s62, v252
    s_and_b32 s35, vcc_lo, 247
    s_cbranch_scc1 L_p2_spin3_a
L_p2_ok3_a:
    buffer_load_dwordx4 v[72:75], v227, s[20:23], s48 offen sc1
    buffer_load_dword v250, v218, s[20:23], s49 offen sc1
    buffer_load_dwordx4 v[76:79], v228, s[20:23], s48 offen sc1
    v_add_u32 v216, 131072, v216
    v_add_u32 v217, 131072, v217
    ds_read_b64_tr_b16 v[104:105], v216 offset:16384
    ds_read_b64_tr_b16 v[106:107], v216 offset:17408
    ds_read_b64_tr_b16 v[108:109], v217 offset:16384
    ds_read_b64_tr_b16 v[110:111], v217 offset:17408
    s_waitcnt vmcnt(5)
    buffer_load_dwordx4 v[80:83], v229, s[20:23], s48 offen sc1
    s_waitcnt lgkmcnt(6)
    v_mfma_f32_32x32x16_bf16 v[0:15], v[112:115], v[100:103], v[0:15]
    s_waitcnt lgkmcnt(4)
    v_mfma_f32_32x32x16_bf16 v[16:31], v[116:119], v[100:103], v[16:31]
    v_subrev_u32 v216, 131072, v216
    v_subrev_u32 v217, 131072, v217
    ds_read_b64_tr_b16 v[112:113], v216 offset:49152
    ds_read_b64_tr_b16 v[114:115], v216 offset:50176
    ds_read_b64_tr_b16 v[116:117], v217 offset:49152
    ds_read_b64_tr_b16 v[118:119], v217 offset:50176
    s_waitcnt vmcnt(5)
    buffer_load_dwordx4 v[84:87], v230, s[20:23], s48 offen sc1
    s_waitcnt lgkmcnt(6)
    v_mfma_f32_32x32x16_bf16 v[0:15], v[104:107], v[64:67], v[0:15]
    s_waitcnt lgkmcnt(4)
    v_mfma_f32_32x32x16_bf16 v[16:31], v[108:111], v[64:67], v[16:31]
    s_barrier
    ds_read_b64_tr_b16 v[104:105], v216 offset:57344
    ds_read_b64_tr_b16 v[106:107], v216 offset:58368
    ds_read_b64_tr_b16 v[108:109], v217 offset:57344
    ds_read_b64_tr_b16 v[110:111], v217 offset:58368
    s_waitcnt vmcnt(5)
    buffer_load_dwordx4 v[88:91], v231, s[20:23], s48 offen sc1
    s_waitcnt lgkmcnt(6)
    v_mfma_f32_32x32x16_bf16 v[0:15], v[112:115], v[68:71], v[0:15]
    s_waitcnt lgkmcnt(4)
    v_mfma_f32_32x32x16_bf16 v[16:31], v[116:119], v[68:71], v[16:31]
    v_add_u32 v216, 131072, v216
    v_add_u32 v217, 131072, v217
    ds_read_b64_tr_b16 v[112:113], v216 offset:24576
    ds_read_b64_tr_b16 v[114:115], v216 offset:25600
    ds_read_b64_tr_b16 v[116:117], v217 offset:24576
    ds_read_b64_tr_b16 v[118:119], v217 offset:25600
    s_waitcnt vmcnt(5)
    buffer_load_dwordx4 v[92:95], v232, s[20:23], s48 offen sc1
    s_waitcnt lgkmcnt(6)
    v_mfma_f32_32x32x16_bf16 v[32:47], v[104:107], v[72:75], 0
    s_waitcnt lgkmcnt(4)
    v_mfma_f32_32x32x16_bf16 v[48:63], v[108:111], v[72:75], 0
    s_waitcnt vmcnt(5)
    v_cmp_ne_u32 vcc, s62, v250
    s_and_b32 s35, vcc_lo, 8
    s_cbranch_scc1 L_p2_spin4_a
L_p2_ok4_a:
    s_add_u32 s48, s48, 8192
    buffer_load_dwordx4 v[96:99], v226, s[20:23], s48 offen sc1
    v_subrev_u32 v216, 65536, v216
    v_subrev_u32 v217, 65536, v217
    ds_read_b64_tr_b16 v[104:105], v216 offset:0
    ds_read_b64_tr_b16 v[106:107], v216 offset:1024
    ds_read_b64_tr_b16 v[108:109], v217 offset:0
    ds_read_b64_tr_b16 v[110:111], v217 offset:1024
    s_waitcnt vmcnt(5)
    buffer_load_dwordx4 v[100:103], v227, s[20:23], s48 offen sc1
    s_waitcnt lgkmcnt(6)
    v_mfma_f32_32x32x16_bf16 v[32:47], v[112:115], v[76:79], v[32:47]
    s_waitcnt lgkmcnt(4)
    v_mfma_f32_32x32x16_bf16 v[48:63], v[116:119], v[76:79], v[48:63]
    v_sub_f32 v224, 1.0, v222
    v_mul_f32 v0, v224, v0
    v_mul_f32 v1, v224, v1
    v_mul_f32 v2, v224, v2
    v_mul_f32 v3, v224, v3
    v_mul_f32 v4, v224, v4
    ds_read_b64_tr_b16 v[112:113], v216 offset:8192
    ds_read_b64_tr_b16 v[114:115], v216 offset:9216
    ds_read_b64_tr_b16 v[116:117], v217 offset:8192
    ds_read_b64_tr_b16 v[118:119], v217 offset:9216
    s_waitcnt vmcnt(5)
    s_waitcnt lgkmcnt(6)
    v_mfma_f32_32x32x16_bf16 v[32:47], v[104:107], v[80:83], v[32:47]
    s_waitcnt lgkmcnt(4)
    v_mfma_f32_32x32x16_bf16 v[48:63], v[108:111], v[80:83], v[48:63]
    v_mul_f32 v5, v224, v5
    v_mul_f32 v6, v224, v6
    v_mul_f32 v7, v224, v7
    v_mul_f32 v8, v224, v8
    v_mul_f32 v9, v224, v9
    v_mul_f32 v10, v224, v10
    v_add_u32 v216, 65536, v216
    v_add_u32 v217, 65536, v217
    ds_read_b64_tr_b16 v[104:105], v216 offset:0
    ds_read_b64_tr_b16 v[106:107], v216 offset:1024
    ds_read_b64_tr_b16 v[108:109], v217 offset:0
    ds_read_b64_tr_b16 v[110:111], v217 offset:1024
    s_waitcnt vmcnt(4)
    s_waitcnt lgkmcnt(6)
    v_mfma_f32_32x32x16_bf16 v[32:47], v[112:115], v[84:87], v[32:47]
    s_waitcnt lgkmcnt(4)
    v_mfma_f32_32x32x16_bf16 v[48:63], v[116:119], v[84:87], v[48:63]
    v_mul_f32 v11, v224, v11
    v_mul_f32 v12, v224, v12
    v_mul_f32 v13, v224, v13
    v_mul_f32 v14, v224, v14
    v_mul_f32 v15, v224, v15
    v_mul_f32 v16, v224, v16
    v_subrev_u32 v216, 65536, v216
    v_subrev_u32 v217, 65536, v217
    ds_read_b64_tr_b16 v[112:113], v216 offset:16384
    ds_read_b64_tr_b16 v[114:115], v216 offset:17408
    ds_read_b64_tr_b16 v[116:117], v217 offset:16384
    ds_read_b64_tr_b16 v[118:119], v217 offset:17408
    s_waitcnt vmcnt(3)
    s_waitcnt lgkmcnt(6)
    v_mfma_f32_32x32x16_bf16 v[32:47], v[104:107], v[88:91], v[32:47]
    s_waitcnt lgkmcnt(4)
    v_mfma_f32_32x32x16_bf16 v[48:63], v[108:111], v[88:91], v[48:63]
    v_mul_f32 v17, v224, v17
    v_mul_f32 v18, v224, v18
    v_mul_f32 v19, v224, v19
    v_mul_f32 v20, v224, v20
    v_mul_f32 v21, v224, v21
    v_mul_f32 v22, v224, v22
    ds_read_b64_tr_b16 v[104:105], v216 offset:24576
    ds_read_b64_tr_b16 v[106:107], v216 offset:25600
    ds_read_b64_tr_b16 v[108:109], v217 offset:24576
    ds_read_b64_tr_b16 v[110:111], v217 offset:25600
    s_waitcnt vmcnt(2)
    s_waitcnt lgkmcnt(6)
    v_mfma_f32_32x32x16_bf16 v[32:47], v[112:115], v[92:95], v[32:47]
    s_waitcnt lgkmcnt(4)
    v_mfma_f32_32x32x16_bf16 v[48:63], v[116:119], v[92:95], v[48:63]
    v_mul_f32 v23, v224, v23
    v_mul_f32 v24, v224, v24
    v_mul_f32 v25, v224, v25
    v_mul_f32 v26, v224, v26
    v_mul_f32 v27, v224, v27
    v_mul_f32 v28, v224, v28
    v_add_u32 v216, 65536, v216
    v_add_u32 v217, 65536, v217
    ds_read_b64_tr_b16 v[112:113], v216 offset:8192
    ds_read_b64_tr_b16 v[114:115], v216 offset:9216
    ds_read_b64_tr_b16 v[116:117], v217 offset:8192
    ds_read_b64_tr_b16 v[118:119], v217 offset:9216
    s_waitcnt vmcnt(1)
    s_waitcnt lgkmcnt(6)
    v_mfma_f32_32x32x16_bf16 v[32:47], v[104:107], v[96:99], v[32:47]
    s_waitcnt lgkmcnt(4)
    v_mfma_f32_32x32x16_bf16 v[48:63], v[108:111], v[96:99], v[48:63]
    v_mul_f32 v29, v224, v29
    v_mul_f32 v30, v224, v30
    v_mul_f32 v31, v224, v31
    s_waitcnt vmcnt(0)
    s_waitcnt lgkmcnt(2)
    v_mfma_f32_32x32x16_bf16 v[32:47], v[112:115], v[100:103], v[32:47]
    s_waitcnt lgkmcnt(0)
    v_mfma_f32_32x32x16_bf16 v[48:63], v[116:119], v[100:103], v[48:63]
L_final:
    s_or_b32 s33, s2, s56
    s_cbranch_scc1 L_fin0
    v_lshrrev_b32 v108, 3, v254
    v_and_b32 v109, 7, v254
    v_lshlrev_b32 v109, 2, v109
    v_lshl_add_u32 v108, v108, 10, v109
    v_add_u32 v109, 4, v109
    v_and_b32 v109, 32, v109
    v_lshl_add_u32 v108, v109, 10, v108
    s_mov_b32 s74, 655360
    s_mov_b32 s75, 663552
    buffer_load_dword v110, v108, s[20:23], s74 offen sc1
    buffer_load_dword v111, v108, s[20:23], s75 offen sc1
L_fin0:
    s_nop 7
    v_pk_fma_f32 v[0:1], v[32:33], v[222:223], v[0:1] op_sel_hi:[1,0,1]
    v_pk_fma_f32 v[2:3], v[34:35], v[222:223], v[2:3] op_sel_hi:[1,0,1]
    ds_write_b128 v120, v[0:3] offset:0
    v_pk_fma_f32 v[4:5], v[36:37], v[222:223], v[4:5] op_sel_hi:[1,0,1]
    v_pk_fma_f32 v[6:7], v[38:39], v[222:223], v[6:7] op_sel_hi:[1,0,1]
    ds_write_b128 v121, v[4:7] offset:0
    v_pk_fma_f32 v[8:9], v[40:41], v[222:223], v[8:9] op_sel_hi:[1,0,1]
    v_pk_fma_f32 v[10:11], v[42:43], v[222:223], v[10:11] op_sel_hi:[1,0,1]
    ds_write_b128 v122, v[8:11] offset:0
    v_pk_fma_f32 v[12:13], v[44:45], v[222:223], v[12:13] op_sel_hi:[1,0,1]
    v_pk_fma_f32 v[14:15], v[46:47], v[222:223], v[14:15] op_sel_hi:[1,0,1]
    ds_write_b128 v123, v[12:15] offset:0
    v_pk_fma_f32 v[16:17], v[48:49], v[222:223], v[16:17] op_sel_hi:[1,0,1]
    v_pk_fma_f32 v[18:19], v[50:51], v[222:223], v[18:19] op_sel_hi:[1,0,1]
    ds_write_b128 v120, v[16:19] offset:128
    v_pk_fma_f32 v[20:21], v[52:53], v[222:223], v[20:21] op_sel_hi:[1,0,1]
    v_pk_fma_f32 v[22:23], v[54:55], v[222:223], v[22:23] op_sel_hi:[1,0,1]
    ds_write_b128 v121, v[20:23] offset:128
    v_pk_fma_f32 v[24:25], v[56:57], v[222:223], v[24:25] op_sel_hi:[1,0,1]
    v_pk_fma_f32 v[26:27], v[58:59], v[222:223], v[26:27] op_sel_hi:[1,0,1]
    ds_write_b128 v122, v[24:27] offset:128
    v_pk_fma_f32 v[28:29], v[60:61], v[222:223], v[28:29] op_sel_hi:[1,0,1]
    v_pk_fma_f32 v[30:31], v[62:63], v[222:223], v[30:31] op_sel_hi:[1,0,1]
    ds_write_b128 v123, v[28:31] offset:128
    s_waitcnt lgkmcnt(0)
    s_barrier
    ds_read_b128 v[64:67], v126 offset:0
    ds_read_b128 v[68:71], v127 offset:0
    ds_read_b128 v[72:75], v126 offset:8192
    ds_read_b128 v[76:79], v127 offset:8192
    ds_read_b128 v[80:83], v126 offset:16384
    ds_read_b128 v[84:87], v127 offset:16384
    ds_read_b128 v[88:91], v126 offset:24576
    ds_read_b128 v[92:95], v127 offset:24576
    s_waitcnt lgkmcnt(4)
    v_pk_add_f32 v[64:65], v[64:65], v[72:73]
    v_pk_add_f32 v[66:67], v[66:67], v[74:75]
    v_pk_add_f32 v[68:69], v[68:69], v[76:77]
    v_pk_add_f32 v[70:71], v[70:71], v[78:79]
    s_waitcnt lgkmcnt(0)
    v_pk_add_f32 v[80:81], v[80:81], v[88:89]
    v_pk_add_f32 v[82:83], v[82:83], v[90:91]
    v_pk_add_f32 v[84:85], v[84:85], v[92:93]
    v_pk_add_f32 v[86:87], v[86:87], v[94:95]
    v_pk_add_f32 v[64:65], v[64:65], v[80:81]
    v_pk_add_f32 v[66:67], v[66:67], v[82:83]
    v_pk_add_f32 v[68:69], v[68:69], v[84:85]
    v_pk_add_f32 v[70:71], v[70:71], v[86:87]
    v_cvt_pk_bf16_f32 v96, v64, v65
    v_cvt_pk_bf16_f32 v97, v66, v67
    v_cvt_pk_bf16_f32 v98, v68, v69
    v_cvt_pk_bf16_f32 v99, v70, v71
    buffer_store_dwordx4 v[96:99], v124, s[24:27], s66 offen sc1
    s_cmp_lg_u32 s33, 0
    s_cbranch_scc1 L_fin1
    s_waitcnt vmcnt(1)
    v_xor_b32 v110, s62, v110
    v_xor_b32 v111, s62, v111
    v_or_b32 v110, v110, v111
    v_cmp_ne_u32 vcc, 0, v110
    s_cbranch_vccz L_fin2
L_poll_30:
    buffer_load_dword v255, v108, s[20:23], s74 offen sc1
    s_waitcnt vmcnt(0)
    v_cmp_ne_u32 vcc, s62, v255
    s_cbranch_vccz L_polled_31
    s_sub_u32 s63, s63, 1
    s_cbranch_scc1 L_polled_31
    s_sleep 1
    s_branch L_poll_30
L_polled_31:
L_poll_32:
    buffer_load_dword v255, v108, s[20:23], s75 offen sc1
    s_waitcnt vmcnt(0)
    v_cmp_ne_u32 vcc, s62, v255
    s_cbranch_vccz L_polled_33
    s_sub_u32 s63, s63, 1
    s_cbranch_scc1 L_polled_33
    s_sleep 1
    s_branch L_poll_32
L_polled_33:
L_fin2:
    s_mov_b32 s64, 0
    v_mov_b32 v253, 0
    v_mov_b32 v255, s62
    s_mov_b64 exec, 1
    buffer_store_dword v255, v253, s[20:23], s64 offen sc1
    s_mov_b64 exec, -1
L_fin1:
L_end:
    s_endpgm
L_p2_lspin_f:
    ds_read_b32 v253, v219
    s_waitcnt lgkmcnt(0)
    v_cmp_ne_u32 vcc, s62, v253
    s_cbranch_vccz L_p2_lok_f
    s_sub_u32 s63, s63, 1
    s_cbranch_scc1 L_p2_lok_f
    s_sleep 1
    s_branch L_p2_lspin_f
L_p2_spin0_f:
L_poll_34:
    buffer_load_dword v255, v218, s[20:23], s46 offen sc1
    s_waitcnt vmcnt(0)
    v_cmp_ne_u32 vcc, s62, v255
    s_and_b32 s35, vcc_lo, 127
    s_cbranch_scc0 L_polled_35
    s_sub_u32 s63, s63, 1
    s_cbranch_scc1 L_polled_35
    s_sleep 1
    s_branch L_poll_34
L_polled_35:
    s_branch L_p2_ok0_f
L_p2_spin1_f:
L_poll_36:
    buffer_load_dword v255, v218, s[20:23], s52 offen sc1
    s_waitcnt vmcnt(0)
    v_cmp_ne_u32 vcc, s62, v255
    s_and_b32 s35, vcc_lo, 127
    s_cbranch_scc0 L_polled_37
    s_sub_u32 s63, s63, 1
    s_cbranch_scc1 L_polled_37
    s_sleep 1
    s_branch L_poll_36
L_polled_37:
    s_branch L_p2_ok1_f
L_p2_spin2_f:
L_poll_38:
    buffer_load_dword v255, v218, s[20:23], s53 offen sc1
    s_waitcnt vmcnt(0)
    v_cmp_ne_u32 vcc, s62, v255
    s_and_b32 s35, vcc_lo, 255
    s_cbranch_scc0 L_polled_39
    s_sub_u32 s63, s63, 1
    s_cbranch_scc1 L_polled_39
    s_sleep 1
    s_branch L_poll_38
L_polled_39:
    s_branch L_p2_ok2_f
L_p2_spin3_f:
L_poll_40:
    buffer_load_dword v255, v218, s[20:23], s49 offen sc1
    s_waitcnt vmcnt(0)
    v_cmp_ne_u32 vcc, s62, v255
    s_and_b32 s35, vcc_lo, 247
    s_cbranch_scc0 L_polled_41
    s_sub_u32 s63, s63, 1
    s_cbranch_scc1 L_polled_41
    s_sleep 1
    s_branch L_poll_40
L_polled_41:
    s_branch L_p2_ok3_f
L_p2_spin4_f:
L_poll_42:
    buffer_load_dword v255, v218, s[20:23], s49 offen sc1
    s_waitcnt vmcnt(0)
    v_cmp_ne_u32 vcc, s62, v255
    s_and_b32 s35, vcc_lo, 8
    s_cbranch_scc0 L_polled_43
    s_sub_u32 s63, s63, 1
    s_cbranch_scc1 L_polled_43
    s_sleep 1
    s_branch L_poll_42
L_polled_43:
    s_branch L_p2_ok4_f
L_p2_lspin_a:
    ds_read_b32 v253, v219
    s_waitcnt lgkmcnt(0)
    v_cmp_ne_u32 vcc, s62, v253
    s_cbranch_vccz L_p2_lok_a
    s_sub_u32 s63, s63, 1
    s_cbranch_scc1 L_p2_lok_a
    s_sleep 1
    s_branch L_p2_lspin_a
L_p2_spin0_a:
L_poll_44:
    buffer_load_dword v255, v218, s[20:23], s46 offen sc1
    s_waitcnt vmcnt(0)
    v_cmp_ne_u32 vcc, s62, v255
    s_and_b32 s35, vcc_lo, 127
    s_cbranch_scc0 L_polled_45
    s_sub_u32 s63, s63, 1
    s_cbranch_scc1 L_polled_45
    s_sleep 1
    s_branch L_poll_44
L_polled_45:
    s_branch L_p2_ok0_a
L_p2_spin1_a:
L_poll_46:
    buffer_load_dword v255, v218, s[20:23], s52 offen sc1
    s_waitcnt vmcnt(0)
    v_cmp_ne_u32 vcc, s62, v255
    s_and_b32 s35, vcc_lo, 127
    s_cbranch_scc0 L_polled_47
    s_sub_u32 s63, s63, 1
    s_cbranch_scc1 L_polled_47
    s_sleep 1
    s_branch L_poll_46
L_polled_47:
    s_branch L_p2_ok1_a
L_p2_spin2_a:
L_poll_48:
    buffer_load_dword v255, v218, s[20:23], s53 offen sc1
    s_waitcnt vmcnt(0)
    v_cmp_ne_u32 vcc, s62, v255
    s_and_b32 s35, vcc_lo, 255
    s_cbranch_scc0 L_polled_49
    s_sub_u32 s63, s63, 1
    s_cbranch_scc1 L_polled_49
    s_sleep 1
    s_branch L_poll_48
L_polled_49:
    s_branch L_p2_ok2_a
L_p2_spin3_a:
L_poll_50:
    buffer_load_dword v255, v218, s[20:23], s49 offen sc1
    s_waitcnt vmcnt(0)
    v_cmp_ne_u32 vcc, s62, v255
    s_and_b32 s35, vcc_lo, 247
    s_cbranch_scc0 L_polled_51
    s_sub_u32 s63, s63, 1
    s_cbranch_scc1 L_polled_51
    s_sleep 1
    s_branch L_poll_50
L_polled_51:
    s_branch L_p2_ok3_a
L_p2_spin4_a:
L_poll_52:
    buffer_load_dword v255, v218, s[20:23], s49 offen sc1
    s_waitcnt vmcnt(0)
    v_cmp_ne_u32 vcc, s62, v255
    s_and_b32 s35, vcc_lo, 8
    s_cbranch_scc0 L_polled_53
    s_sub_u32 s63, s63, 1
    s_cbranch_scc1 L_polled_53
    s_sleep 1
    s_branch L_poll_52
L_polled_53:
    s_branch L_p2_ok4_a
L_code_end:
.section .rodata,"a"
.p2align 6
.amdhsa_kernel gated_mix__linear_attn_block__dense_activation_silu__prompt_kernel
  .amdhsa_next_free_vgpr 256
  .amdhsa_next_free_sgpr 102
  .amdhsa_accum_offset 256
  .amdhsa_group_segment_fixed_size 0
  .amdhsa_kernarg_size 80
  .amdhsa_user_sgpr_count 2
  .amdhsa_user_sgpr_kernarg_segment_ptr 1
  .amdhsa_system_sgpr_workgroup_id_x 1
.end_amdhsa_kernel
```
